```python
import torch

def _softmax(x, axis=-1):
    return torch.softmax(x, dim=axis)
def _gelu(x):
    return torch.nn.functional.gelu(x, approximate="tanh")
def _silu(x):
    return torch.nn.functional.silu(x)
def _sigmoid(x):
    return torch.sigmoid(x)
def _layernorm(x, axis=-1, eps=1e-5):
    m = x.mean(dim=axis, keepdim=True)
    v = x.var(dim=axis, keepdim=True, unbiased=False)
    return (x - m) / torch.sqrt(v + eps)
def _scatter_add(tgt, idx, src, axis=0):
    return tgt.clone().index_add_(axis, idx, src)
def _segment_sum(src, seg, n):
    out = torch.zeros((n,) + src.shape[1:], dtype=src.dtype)
    return out.index_add_(0, seg, src)
def _pad(x, pw):
    flat = tuple(v for pair in reversed(pw) for v in pair)
    return torch.nn.functional.pad(x, flat)

kernel_name = 'recurrent_scan__sliding_block_cached__geglu_ffn__decode'

def setup_inputs():

    _w = (lambda a: (lambda t: t.to(torch.bfloat16) if t.is_floating_point() else t)(torch.as_tensor(a)))
    def _A_setup():
        B, Sq, D = 1, 1, 512
        Hq, Hkv, Sk, Dh = 32, 8, 32768, 128
        assert Hq % Hkv == 0, (Hq, Hkv)
        return {
            "x": _w((lambda *s: torch.randn(*s, dtype=torch.bfloat16) * 0.05)(B, Sq, D)),
            "k_cache": _w((lambda *s: torch.randn(*s, dtype=torch.bfloat16) * 1.6)(B, Hkv, Sk, Dh)),
            "v_cache": _w((lambda *s: torch.randn(*s, dtype=torch.bfloat16) * 0.2)(B, Hkv, Sk, Dh)),
            "wq": _w((lambda *s: torch.randn(*s, dtype=torch.bfloat16) * 1.6)(D, Hq * Dh) * (D ** -0.5)),
            "wo": _w((lambda *s: torch.randn(*s, dtype=torch.bfloat16) * 0.2)(Hq * Dh, D) * ((Hq * Dh) ** -0.5)),
        }
    _A_in = _A_setup()

    def _B_setup():
        B, S, D, F = 1, 1, 512, 1792
        return {
            "x": _w((lambda *s: torch.randn(*s, dtype=torch.bfloat16) * 0.05)(B, S, D)),
            "w_gate": _w((lambda *s: torch.randn(*s, dtype=torch.bfloat16) * 0.1)(D, F)),
            "w_up": _w((lambda *s: torch.randn(*s, dtype=torch.bfloat16) * 0.1)(D, F)),
            "w_down": _w((lambda *s: torch.randn(*s, dtype=torch.bfloat16) * 0.1)(F, D)),
        }
    _B_in = _B_setup()

    return {
        "A_x": _A_in["x"],
        "A_k_cache": _A_in["k_cache"],
        "A_v_cache": _A_in["v_cache"],
        "A_wq": _A_in["wq"],
        "A_wo": _A_in["wo"],
        "B_x": _B_in["x"],
        "B_w_gate": _B_in["w_gate"],
        "B_w_up": _B_in["w_up"],
        "B_w_down": _B_in["w_down"],
    }

def reference(A_x, A_k_cache, A_v_cache, A_wq, A_wo, B_x, B_w_gate, B_w_up, B_w_down):
    def _A_ref(x, k_cache, v_cache, wq, wo):
        B, Sq, D = x.shape
        Hq, Dh = 32, 128
        Hkv, Sk = k_cache.shape[1], k_cache.shape[2]
        W = min(4096, max(256, Sk // 4))
        rep = Hq // Hkv
        q = (lambda x, *d: x.permute(*d))((x @ wq).reshape(B, Sq, Hq, Dh), 0, 2, 1, 3)
        k = (lambda x, n, axis: torch.repeat_interleave(x, n, dim=axis))(k_cache[:, :, Sk - W:, :], rep, axis=1)
        v = (lambda x, n, axis: torch.repeat_interleave(x, n, dim=axis))(v_cache[:, :, Sk - W:, :], rep, axis=1)
        scores = torch.einsum("bhqd,bhkd->bhqk", q, k) * (Dh ** -0.5)
        p = _softmax(scores, axis=-1)
        o = torch.einsum("bhqk,bhkd->bhqd", p, v)
        return (lambda x, *d: x.permute(*d))(o, 0, 2, 1, 3).reshape(B, Sq, Hq * Dh) @ wo

    def _B_ref(x, w_gate, w_up, w_down):
        return (_gelu(x @ w_gate) * (x @ w_up)) @ w_down

    x = A_x
    xn = _layernorm(x, axis=-1)
    s = _A_ref(xn, A_k_cache, A_v_cache, A_wq, A_wo)
    g = _silu(_B_ref(xn, B_w_gate, B_w_up, B_w_down))
    return x + s * g
```

```asm
; @launch grid=(256,1,1) block=(704,1,1) lds=135168
.amdgcn_target "amdgcn-amd-amdhsa--gfx950"
.text
.globl recurrent_scan__sliding_block_cached__geglu_ffn__decode_kernel
.p2align 12
.type recurrent_scan__sliding_block_cached__geglu_ffn__decode_kernel,@function
recurrent_scan__sliding_block_cached__geglu_ffn__decode_kernel:
  s_load_dwordx16 s[8:23], s[0:1], 0
  s_load_dwordx8 s[24:31], s[0:1], 64
  v_lshrrev_b32 v2, 6, v0
  v_and_b32 v1, 63, v0
  v_readfirstlane_b32 s3, v2
  s_lshr_b32 s5, s2, 3
  v_mov_b32 v7, 0
  s_cmp_ge_u32 s5, 32
  s_cbranch_scc1 L_quit
  s_and_b32 s4, s2, 7
  s_cmp_eq_u32 s3, 1
  s_cbranch_scc1 L_N
  s_cmp_eq_u32 s3, 2
  s_cbranch_scc1 L_Q
  s_cmp_eq_u32 s3, 3
  s_cbranch_scc1 T_L2
  s_cmp_eq_u32 s3, 4
  s_cbranch_scc1 T_LL
  s_cmp_eq_u32 s3, 0
  s_cbranch_scc1 L_L
  s_cmp_eq_u32 s3, 10
  s_cbranch_scc1 L_tag
L_bar:
  s_barrier
L_go:
  s_sub_u32 s46, s3, 7
  s_cmp_eq_u32 s46, 0
  s_cbranch_scc1 T_G
  s_cmp_eq_u32 s46, 1
  s_cbranch_scc1 T_F2
  s_cmp_eq_u32 s46, 2
  s_cbranch_scc1 T_Ap
  s_cmp_eq_u32 s46, 3
  s_cbranch_scc1 T_Wp
  s_sub_u32 s46, s3, 3
  s_branch L_A
L_tag:
  s_getpc_b64 s[40:41]
L_pc:
  s_sub_u32 s40, s40, L_pc-recurrent_scan__sliding_block_cached__geglu_ffn__decode_kernel
  s_subb_u32 s41, s41, 0
  s_mul_i32 s42, s5, 4
  v_add_u32 v12, s42, v1
  v_and_b32 v12, 127, v12
  v_lshlrev_b32 v12, 7, v12
  s_mov_b64 exec, 15
  global_load_dword v121, v12, s[40:41]
  s_mov_b64 exec, -1
  s_waitcnt lgkmcnt(0)
  s_load_dword s6, s[30:31], 0
  s_barrier
  s_waitcnt lgkmcnt(0)
  s_add_u32 s6, s6, 0x9e3779b8
  s_or_b32 s6, s6, 1
  v_mov_b32 v11, s6
  ds_write_b32 v7, v11 offset:0
  s_branch L_go
L_quit:
  s_endpgm
L_L:
  s_setprio 3
  v_lshrrev_b32 v3, 3, v1
  v_and_b32 v4, 6, v3
  v_and_b32 v5, 7, v1
  v_xor_b32 v4, v4, v5
  v_lshlrev_b32 v4, 4, v4
  s_and_b32 s40, s5, 3
  s_lshl_b32 s40, s40, 20
  s_lshl_b32 s41, s4, 10
  s_add_u32 s40, s40, s41
  s_lshr_b32 s41, s5, 2
  s_lshl_b32 s41, s41, 7
  s_add_u32 s40, s40, s41
  v_lshl_add_u32 v8, v3, 13, v4
  v_add_u32 v8, s40, v8
  v_lshlrev_b32 v29, 2, v1
  ds_write_b32 v29, v7
  s_mov_b32 s41, 64512
  v_add_u32 v9, s41, v8
  v_add_u32 v10, s41, v9
  v_add_u32 v11, s41, v10
  v_lshrrev_b32 v5, 4, v1
  v_and_b32 v6, 15, v1
  v_xor_b32 v12, v5, v6
  v_lshlrev_b32 v12, 4, v12
  v_lshlrev_b32 v2, 8, v5
  v_add_u32 v12, v2, v12
  v_xor_b32 v13, 64, v12
  v_add_u32 v13, 31744, v13
  v_xor_b32 v14, 128, v12
  v_add_u32 v14, 63488, v14
  v_xor_b32 v15, 192, v12
  v_add_u32 v15, 95232, v15
  s_lshl_b32 s40, s4, 23
  s_lshl_b32 s41, s5, 10
  s_add_u32 s40, s40, s41
  s_add_u32 s47, s40, 7340032
  v_lshlrev_b32 v29, 4, v1
  s_mov_b32 m0, 10240
  s_waitcnt lgkmcnt(0)
  global_load_lds_dwordx4 v29, s[8:9] offset:0
  s_mov_b32 m0, 12288
  s_nop 0
  global_load_lds_dwordx4 v8, s[14:15] offset:0 nt
  global_load_lds_dwordx4 v9, s[14:15] offset:1024 nt
  global_load_lds_dwordx4 v10, s[14:15] offset:2048 nt
  global_load_lds_dwordx4 v11, s[14:15] offset:3072 nt
  s_mov_b32 m0, 16384
  s_add_u32 s14, s14, 262144
  s_addc_u32 s15, s15, 0
  global_load_lds_dwordx4 v8, s[14:15] offset:0 nt
  global_load_lds_dwordx4 v9, s[14:15] offset:1024 nt
  global_load_lds_dwordx4 v10, s[14:15] offset:2048 nt
  global_load_lds_dwordx4 v11, s[14:15] offset:3072 nt
  s_mov_b32 m0, 20480
  s_add_u32 s14, s14, 262144
  s_addc_u32 s15, s15, 0
  global_load_lds_dwordx4 v8, s[14:15] offset:0 nt
  global_load_lds_dwordx4 v9, s[14:15] offset:1024 nt
  global_load_lds_dwordx4 v10, s[14:15] offset:2048 nt
  global_load_lds_dwordx4 v11, s[14:15] offset:3072 nt
  s_mov_b32 m0, 24576
  s_add_u32 s14, s14, 262144
  s_addc_u32 s15, s15, 0
  global_load_lds_dwordx4 v8, s[14:15] offset:0 nt
  global_load_lds_dwordx4 v9, s[14:15] offset:1024 nt
  global_load_lds_dwordx4 v10, s[14:15] offset:2048 nt
  global_load_lds_dwordx4 v11, s[14:15] offset:3072 nt
  s_mov_b32 m0, 28672
  s_add_u32 s10, s10, s47
  s_addc_u32 s11, s11, 0
  global_load_lds_dwordx4 v12, s[10:11] offset:0 nt
  global_load_lds_dwordx4 v13, s[10:11] offset:1024 nt
  global_load_lds_dwordx4 v14, s[10:11] offset:2048 nt
  global_load_lds_dwordx4 v15, s[10:11] offset:3072 nt
  s_mov_b32 m0, 32768
  s_add_u32 s10, s10, 131072
  s_addc_u32 s11, s11, 0
  global_load_lds_dwordx4 v12, s[10:11] offset:0 nt
  global_load_lds_dwordx4 v13, s[10:11] offset:1024 nt
  global_load_lds_dwordx4 v14, s[10:11] offset:2048 nt
  global_load_lds_dwordx4 v15, s[10:11] offset:3072 nt
  v_lshlrev_b32 v16, 1, v5
  v_xor_b32 v16, v16, v6
  v_lshlrev_b32 v16, 4, v16
  v_add_u32 v16, v2, v16
  v_xor_b32 v17, 128, v16
  v_add_u32 v18, 63488, v16
  v_add_u32 v19, 95232, v17
  v_add_u32 v17, 31744, v17
  v_mul_u32_u24 v20, 3584, v3
  v_add_u32 v20, v20, v4
  v_lshl_add_u32 v24, v3, 10, v4
  v_add_u32 v21, 27648, v20
  v_add_u32 v25, 7168, v24
  v_add_u32 v22, 27648, v21
  v_add_u32 v26, 7168, v25
  v_add_u32 v23, 27648, v22
  v_add_u32 v27, 7168, v26
  s_add_u32 s12, s12, s47
  s_addc_u32 s13, s13, 0
  s_and_b32 s43, s5, 24
  s_add_u32 s44, s4, 7
  s_and_b32 s44, s44, 7
  s_lshr_b32 s62, s5, 3
  s_lshl2_add_u32 s44, s44, s62
  s_cmp_ge_u32 s44, 28
  s_cselect_b64 s[62:63], 1, -1
  s_min_u32 s44, s44, 27
  s_and_b32 s45, s5, 7
  s_lshl_b32 s42, s45, 7
  s_mul_i32 s40, s45, 229376
  s_lshl_b32 s41, s44, 7
  s_add_u32 s40, s40, s41
  s_add_u32 s20, s20, s40
  s_addc_u32 s21, s21, 0
  s_add_u32 s22, s22, s40
  s_addc_u32 s23, s23, 0
  s_lshl_b32 s40, s44, 16
  s_add_u32 s40, s40, s42
  s_add_u32 s24, s24, s40
  s_addc_u32 s25, s25, 0
  s_lshl_b32 s40, s4, 19
  s_lshl_b32 s41, s43, 14
  s_add_u32 s40, s40, s41
  s_add_u32 s40, s40, s42
  s_add_u32 s16, s16, s40
  s_addc_u32 s17, s17, 0
  s_barrier
  s_cmp_eq_u32 s62, 1
  s_cbranch_scc1 L_LL
  s_mov_b32 m0, 61440
  s_nop 0
  v_mov_b32 v28, 1
  s_waitcnt vmcnt(24)
  ds_write_b32 v7, v28 offset:56
  s_waitcnt vmcnt(19)
  global_load_lds_dwordx4 v20, s[20:21] offset:0 nt
  s_waitcnt vmcnt(19)
  global_load_lds_dwordx4 v21, s[20:21] offset:1024 nt
  s_branch L_L2
L_N:
  s_setprio 3
  v_lshlrev_b32 v2, 4, v1
  v_lshrrev_b32 v32, 2, v1
  v_lshlrev_b32 v32, 6, v32
  v_and_b32 v12, 1, v1
  v_lshl_add_u32 v32, v12, 5, v32
  v_and_b32 v12, 2, v1
  v_lshl_add_u32 v32, v12, 2, v32
  v_add_u32 v32, 2048, v32
  v_mov_b32 v33, 1
  s_and_b32 s43, s5, 24
  s_add_u32 s44, s4, 7
  s_and_b32 s44, s44, 7
  s_lshr_b32 s62, s5, 3
  s_lshl2_add_u32 s44, s44, s62
  s_barrier
L_xw_1:
  ds_read_b32 v13, v7 offset:56
  ds_read_b128 v[40:43], v2 offset:10240
  s_waitcnt lgkmcnt(0)
  v_readfirstlane_b32 s7, v13
  s_nop 0
  s_cmp_eq_u32 s7, 0
  s_cbranch_scc1 L_xw_1
  v_lshlrev_b32 v8, 16, v40
  v_and_b32 v9, 0xffff0000, v40
  v_lshlrev_b32 v10, 16, v41
  v_and_b32 v11, 0xffff0000, v41
  v_lshlrev_b32 v12, 16, v42
  v_and_b32 v13, 0xffff0000, v42
  v_lshlrev_b32 v14, 16, v43
  v_and_b32 v15, 0xffff0000, v43
  v_readfirstlane_b32 s40, v8
  s_nop 0
  s_mov_b32 s41, s40
  v_pk_add_f32 v[16:17], v[8:9], s[40:41] neg_lo:[0,1] neg_hi:[0,1]
  v_pk_add_f32 v[18:19], v[10:11], s[40:41] neg_lo:[0,1] neg_hi:[0,1]
  v_pk_add_f32 v[20:21], v[12:13], s[40:41] neg_lo:[0,1] neg_hi:[0,1]
  v_pk_add_f32 v[22:23], v[14:15], s[40:41] neg_lo:[0,1] neg_hi:[0,1]
  v_pk_mul_f32 v[26:27], v[16:17], v[16:17]
  v_pk_mul_f32 v[28:29], v[18:19], v[18:19]
  v_pk_add_f32 v[24:25], v[16:17], v[18:19]
  v_pk_add_f32 v[30:31], v[20:21], v[22:23]
  v_pk_fma_f32 v[26:27], v[20:21], v[20:21], v[26:27]
  v_pk_fma_f32 v[28:29], v[22:23], v[22:23], v[28:29]
  v_pk_add_f32 v[24:25], v[24:25], v[30:31]
  v_pk_add_f32 v[26:27], v[26:27], v[28:29]
  v_add_f32 v24, v24, v25
  v_add_f32 v26, v26, v27
  s_nop 0
  v_add_f32_dpp v24, v24, v24 quad_perm:[1,0,3,2] row_mask:0xf bank_mask:0xf
  v_add_f32_dpp v26, v26, v26 quad_perm:[1,0,3,2] row_mask:0xf bank_mask:0xf
  s_nop 0
  v_add_f32_dpp v24, v24, v24 quad_perm:[2,3,0,1] row_mask:0xf bank_mask:0xf
  v_add_f32_dpp v26, v26, v26 quad_perm:[2,3,0,1] row_mask:0xf bank_mask:0xf
  s_nop 0
  v_add_f32_dpp v24, v24, v24 row_half_mirror row_mask:0xf bank_mask:0xf
  v_add_f32_dpp v26, v26, v26 row_half_mirror row_mask:0xf bank_mask:0xf
  s_nop 0
  v_add_f32_dpp v24, v24, v24 row_mirror row_mask:0xf bank_mask:0xf
  v_add_f32_dpp v26, v26, v26 row_mirror row_mask:0xf bank_mask:0xf
  s_nop 0
  v_add_f32_dpp v24, v24, v24 row_bcast:15 row_mask:0xa bank_mask:0xf
  v_add_f32_dpp v26, v26, v26 row_bcast:15 row_mask:0xa bank_mask:0xf
  s_nop 0
  v_add_f32_dpp v24, v24, v24 row_bcast:31 row_mask:0xc bank_mask:0xf
  v_add_f32_dpp v26, v26, v26 row_bcast:31 row_mask:0xc bank_mask:0xf
  v_mul_f32 v24, 0x3b000000, v24
  v_mul_f32 v26, 0x3b000000, v26
  v_add_f32 v25, s40, v24
  v_fma_f32 v26, -v24, v24, v26
  v_cvt_pk_bf16_f32 v25, v25, v26
  v_and_b32 v26, 0xffff0000, v25
  v_lshlrev_b32 v25, 16, v25
  v_add_f32 v26, 0x3727c5ac, v26
  v_readlane_b32 s40, v25, 63
  v_cvt_pk_bf16_f32 v26, v26, v26
  s_mov_b32 s41, s40
  v_lshlrev_b32 v26, 16, v26
  v_pk_add_f32 v[8:9], v[8:9], s[40:41] neg_lo:[0,1] neg_hi:[0,1]
  v_sqrt_f32 v26, v26
  v_pk_add_f32 v[10:11], v[10:11], s[40:41] neg_lo:[0,1] neg_hi:[0,1]
  v_pk_add_f32 v[12:13], v[12:13], s[40:41] neg_lo:[0,1] neg_hi:[0,1]
  v_pk_add_f32 v[14:15], v[14:15], s[40:41] neg_lo:[0,1] neg_hi:[0,1]
  v_cvt_pk_bf16_f32 v26, v26, v26
  v_cvt_pk_bf16_f32 v20, v8, v9
  v_lshlrev_b32 v26, 16, v26
  v_cvt_pk_bf16_f32 v21, v10, v11
  v_rcp_f32 v26, v26
  v_cvt_pk_bf16_f32 v22, v12, v13
  v_cvt_pk_bf16_f32 v23, v14, v15
  v_readlane_b32 s40, v26, 63
  v_lshlrev_b32 v8, 16, v20
  v_and_b32 v9, 0xffff0000, v20
  s_mov_b32 s41, s40
  v_lshlrev_b32 v10, 16, v21
  v_and_b32 v11, 0xffff0000, v21
  v_lshlrev_b32 v12, 16, v22
  v_and_b32 v13, 0xffff0000, v22
  v_lshlrev_b32 v14, 16, v23
  v_and_b32 v15, 0xffff0000, v23
  v_pk_mul_f32 v[8:9], v[8:9], s[40:41]
  v_pk_mul_f32 v[10:11], v[10:11], s[40:41]
  v_pk_mul_f32 v[12:13], v[12:13], s[40:41]
  v_pk_mul_f32 v[14:15], v[14:15], s[40:41]
  v_cvt_pk_bf16_f32 v20, v8, v9
  v_cvt_pk_bf16_f32 v21, v10, v11
  v_cvt_pk_bf16_f32 v22, v12, v13
  v_cvt_pk_bf16_f32 v23, v14, v15
  ds_write2_b64 v32, v[20:21], v[22:23] offset0:0 offset1:2
  ds_write_b32 v7, v33 offset:4
  s_setprio 0
  s_branch L_sent_3
L_spin_2:
  s_sleep 2
L_sent_3:
  ds_read_b32 v12, v7 offset:0
  s_waitcnt lgkmcnt(0)
  v_readfirstlane_b32 s6, v12
  s_nop 0
  s_cmp_lt_u32 s6, 1
  s_cbranch_scc1 L_spin_2
  s_cmp_ge_u32 s44, 28
  s_cbranch_scc1 L_Z
  s_branch L_F2
L_Q:
  s_setprio 2
  v_and_b32 v3, 15, v1
  v_lshrrev_b32 v4, 4, v1
  s_mov_b32 s52, 0x07060503
  s_mov_b32 s53, 0x07060502
  s_mov_b32 s54, 0x07060501
  s_mov_b32 s55, 0x04000c0c
  s_mov_b32 s56, 0x0706000c
  v_lshrrev_b32 v12, 2, v1
  v_lshlrev_b32 v12, 7, v12
  v_and_b32 v13, 3, v1
  v_lshl_add_u32 v12, v13, 3, v12
  v_bfe_u32 v13, v1, 3, 2
  v_lshl_add_u32 v12, v13, 5, v12
  v_add_u32 v16, 12288, v12
  v_xor_b32 v17, 32, v16
  v_xor_b32 v18, 64, v16
  v_xor_b32 v19, 96, v16
  s_and_b32 s40, s5, 3
  s_lshl_b32 s41, s40, 8
  s_add_u32 s41, s41, 2048
  v_lshlrev_b32 v20, 4, v4
  v_add_u32 v20, s41, v20
  s_lshl_b32 s41, s4, 13
  s_add_u32 s41, s41, 65536
  v_lshlrev_b32 v22, 4, v1
  v_add_u32 v22, s41, v22
  v_add_u32 v23, 4096, v22
  s_lshl_b32 s40, s40, 11
  s_add_u32 s41, s41, s40
  s_lshr_b32 s40, s5, 2
  s_lshl_b32 s40, s40, 8
  s_add_u32 s41, s41, s40
  v_lshlrev_b32 v21, 4, v3
  v_add_u32 v21, s41, v21
  v_lshrrev_b32 v12, 1, v4
  v_mul_u32_u24 v2, 320, v12
  v_and_b32 v12, 1, v4
  v_lshl_add_u32 v2, v12, 7, v2
  v_lshl_add_u32 v2, v3, 1, v2
  s_lshl_b32 s40, s4, 7
  s_add_u32 s40, s40, 32768
  v_and_b32 v5, 31, v1
  v_lshlrev_b32 v5, 2, v5
  v_add_u32 v5, s40, v5
  s_lshl_b64 s[58:59], 1, s5
  s_getreg_b32 s48, hwreg(HW_REG_XCC_ID, 0, 4)
  s_barrier
  s_waitcnt lgkmcnt(0)
  s_add_u32 s32, s30, 4194304
  s_addc_u32 s33, s31, 0
  v_mov_b32 v13, v21
  v_writelane_b32 v13, s40, 1
  s_mov_b64 exec, 0x103
  global_load_dword v14, v13, s[32:33] sc1
  s_mov_b64 exec, -1
  s_branch L_sent_5
L_spin_4:
L_sent_5:
  ds_read_b32 v12, v7 offset:60
  s_waitcnt lgkmcnt(0)
  v_readfirstlane_b32 s7, v12
  s_nop 0
  s_cmp_lt_u32 s7, 8
  s_cbranch_scc1 L_spin_4
  ds_read_b64_tr_b16 v[24:25], v16 offset:0
  ds_read_b64_tr_b16 v[26:27], v16 offset:2048
  ds_read_b64_tr_b16 v[28:29], v17 offset:0
  ds_read_b64_tr_b16 v[30:31], v17 offset:2048
  ds_read_b64_tr_b16 v[32:33], v18 offset:0
  ds_read_b64_tr_b16 v[34:35], v18 offset:2048
  ds_read_b64_tr_b16 v[36:37], v19 offset:0
  ds_read_b64_tr_b16 v[38:39], v19 offset:2048
  ds_read_b64_tr_b16 v[40:41], v16 offset:4096
  ds_read_b64_tr_b16 v[42:43], v16 offset:6144
  ds_read_b64_tr_b16 v[44:45], v17 offset:4096
  ds_read_b64_tr_b16 v[46:47], v17 offset:6144
  ds_read_b64_tr_b16 v[48:49], v18 offset:4096
  ds_read_b64_tr_b16 v[50:51], v18 offset:6144
  ds_read_b64_tr_b16 v[52:53], v19 offset:4096
  ds_read_b64_tr_b16 v[54:55], v19 offset:6144
L_xspin_6:
  ds_read_b64 v[12:13], v7 offset:0
  ds_read_b128 v[88:91], v20 offset:0
  ds_read_b128 v[92:95], v20 offset:64
  ds_read_b128 v[96:99], v20 offset:128
  ds_read_b128 v[100:103], v20 offset:192
  s_waitcnt lgkmcnt(0)
  v_readfirstlane_b32 s6, v12
  v_readfirstlane_b32 s7, v13
  s_nop 0
  s_and_b32 s7, s7, s6
  s_cmp_eq_u32 s7, 0
  s_cbranch_scc1 L_xspin_6
  v_mov_b32 v11, s6
  s_add_u32 s48, s48, s6
  v_mov_b32 v6, s48
  ds_read_b32 v13, v7 offset:60
  ds_read_b64_tr_b16 v[56:57], v16 offset:8192
  ds_read_b64_tr_b16 v[58:59], v16 offset:10240
  ds_read_b64_tr_b16 v[60:61], v17 offset:8192
  ds_read_b64_tr_b16 v[62:63], v17 offset:10240
  ds_read_b64_tr_b16 v[64:65], v18 offset:8192
  ds_read_b64_tr_b16 v[66:67], v18 offset:10240
  ds_read_b64_tr_b16 v[68:69], v19 offset:8192
  ds_read_b64_tr_b16 v[70:71], v19 offset:10240
  ds_read_b64_tr_b16 v[72:73], v16 offset:12288
  ds_read_b64_tr_b16 v[74:75], v16 offset:14336
  ds_read_b64_tr_b16 v[76:77], v17 offset:12288
  ds_read_b64_tr_b16 v[78:79], v17 offset:14336
  ds_read_b64_tr_b16 v[80:81], v18 offset:12288
  ds_read_b64_tr_b16 v[82:83], v18 offset:14336
  ds_read_b64_tr_b16 v[84:85], v19 offset:12288
  ds_read_b64_tr_b16 v[86:87], v19 offset:14336
  v_mfma_f32_16x16x32_bf16 v[104:107], v[88:91], v[24:27], 0
  v_mfma_f32_16x16x32_bf16 v[108:111], v[88:91], v[28:31], 0
  v_mfma_f32_16x16x32_bf16 v[112:115], v[88:91], v[32:35], 0
  v_mfma_f32_16x16x32_bf16 v[116:119], v[88:91], v[36:39], 0
  v_mfma_f32_16x16x32_bf16 v[104:107], v[92:95], v[40:43], v[104:107]
  v_mfma_f32_16x16x32_bf16 v[108:111], v[92:95], v[44:47], v[108:111]
  v_mfma_f32_16x16x32_bf16 v[112:115], v[92:95], v[48:51], v[112:115]
  v_mfma_f32_16x16x32_bf16 v[116:119], v[92:95], v[52:55], v[116:119]
  s_mov_b64 exec, s[58:59]
  global_store_dword v5, v6, s[32:33]
  s_mov_b64 exec, -1
  s_branch L_q2e_8
L_q2_7:
  ds_read_b32 v13, v7 offset:60
  ds_read_b64_tr_b16 v[56:57], v16 offset:8192
  ds_read_b64_tr_b16 v[58:59], v16 offset:10240
  ds_read_b64_tr_b16 v[60:61], v17 offset:8192
  ds_read_b64_tr_b16 v[62:63], v17 offset:10240
  ds_read_b64_tr_b16 v[64:65], v18 offset:8192
  ds_read_b64_tr_b16 v[66:67], v18 offset:10240
  ds_read_b64_tr_b16 v[68:69], v19 offset:8192
  ds_read_b64_tr_b16 v[70:71], v19 offset:10240
  ds_read_b64_tr_b16 v[72:73], v16 offset:12288
  ds_read_b64_tr_b16 v[74:75], v16 offset:14336
  ds_read_b64_tr_b16 v[76:77], v17 offset:12288
  ds_read_b64_tr_b16 v[78:79], v17 offset:14336
  ds_read_b64_tr_b16 v[80:81], v18 offset:12288
  ds_read_b64_tr_b16 v[82:83], v18 offset:14336
  ds_read_b64_tr_b16 v[84:85], v19 offset:12288
  ds_read_b64_tr_b16 v[86:87], v19 offset:14336
L_q2e_8:
  s_waitcnt lgkmcnt(0)
  v_readfirstlane_b32 s7, v13
  s_nop 0
  s_cmp_lt_u32 s7, 16
  s_cbranch_scc1 L_q2_7
  v_mfma_f32_16x16x32_bf16 v[104:107], v[96:99], v[56:59], v[104:107]
  v_mfma_f32_16x16x32_bf16 v[108:111], v[96:99], v[60:63], v[108:111]
  v_mfma_f32_16x16x32_bf16 v[112:115], v[96:99], v[64:67], v[112:115]
  v_mfma_f32_16x16x32_bf16 v[116:119], v[96:99], v[68:71], v[116:119]
  v_mfma_f32_16x16x32_bf16 v[104:107], v[100:103], v[72:75], v[104:107]
  v_mfma_f32_16x16x32_bf16 v[108:111], v[100:103], v[76:79], v[108:111]
  v_mfma_f32_16x16x32_bf16 v[112:115], v[100:103], v[80:83], v[112:115]
  v_mfma_f32_16x16x32_bf16 v[116:119], v[100:103], v[84:87], v[116:119]
  s_nop 7
  v_perm_b32 v8, v104, v116, s52
  v_perm_b32 v9, v108, v116, s53
  v_perm_b32 v10, v112, v116, s54
  s_mov_b64 exec, 0xffff
  global_store_dwordx4 v21, v[8:11], s[32:33]
  v_mov_b32 v123, v21
  v_mov_b64 v[124:125], v[8:9]
  v_mov_b64 v[126:127], v[10:11]
  s_mov_b64 exec, -1
  s_branch L_G
T_L2:
  s_branch L_bar
L_L2:
  s_waitcnt vmcnt(19)
  global_load_lds_dwordx4 v22, s[20:21] offset:2048 nt
  v_mov_b32 v28, 8
  s_waitcnt vmcnt(19)
  ds_write_b32 v7, v28 offset:60
  global_load_lds_dwordx4 v23, s[20:21] offset:3072 nt
  s_mov_b32 m0, 36864
  s_add_u32 s10, s10, 131072
  s_addc_u32 s11, s11, 0
  s_waitcnt vmcnt(19)
  global_load_lds_dwordx4 v12, s[10:11] offset:0 nt
  s_waitcnt vmcnt(19)
  global_load_lds_dwordx4 v13, s[10:11] offset:1024 nt
  s_waitcnt vmcnt(19)
  global_load_lds_dwordx4 v14, s[10:11] offset:2048 nt
  v_mov_b32 v28, 12
  s_waitcnt vmcnt(19)
  ds_write_b32 v7, v28 offset:60
  global_load_lds_dwordx4 v15, s[10:11] offset:3072 nt
  s_mov_b32 m0, 40960
  s_add_u32 s10, s10, 131072
  s_addc_u32 s11, s11, 0
  s_waitcnt vmcnt(19)
  global_load_lds_dwordx4 v12, s[10:11] offset:0 nt
  s_waitcnt vmcnt(19)
  global_load_lds_dwordx4 v13, s[10:11] offset:1024 nt
  s_waitcnt vmcnt(19)
  global_load_lds_dwordx4 v14, s[10:11] offset:2048 nt
  v_mov_b32 v28, 16
  s_waitcnt vmcnt(19)
  ds_write_b32 v7, v28 offset:60
  global_load_lds_dwordx4 v15, s[10:11] offset:3072 nt
  s_mov_b32 m0, 65536
  s_add_u32 s20, s20, 114688
  s_addc_u32 s21, s21, 0
  s_waitcnt vmcnt(19)
  global_load_lds_dwordx4 v20, s[20:21] offset:0 nt
  s_waitcnt vmcnt(19)
  global_load_lds_dwordx4 v21, s[20:21] offset:1024 nt
  s_waitcnt vmcnt(19)
  global_load_lds_dwordx4 v22, s[20:21] offset:2048 nt
  v_mov_b32 v28, 4
  s_waitcnt vmcnt(19)
  ds_write_b32 v7, v28 offset:8
  global_load_lds_dwordx4 v23, s[20:21] offset:3072 nt
  s_mov_b32 m0, 45056
  s_add_u32 s10, s10, 131072
  s_addc_u32 s11, s11, 0
  s_waitcnt vmcnt(19)
  global_load_lds_dwordx4 v12, s[10:11] offset:0 nt
  s_waitcnt vmcnt(19)
  global_load_lds_dwordx4 v13, s[10:11] offset:1024 nt
  s_waitcnt vmcnt(19)
  global_load_lds_dwordx4 v14, s[10:11] offset:2048 nt
  v_mov_b32 v28, 8
  s_waitcnt vmcnt(19)
  ds_write_b32 v7, v28 offset:8
  global_load_lds_dwordx4 v15, s[10:11] offset:3072 nt
  s_mov_b32 m0, 49152
  s_add_u32 s10, s10, 131072
  s_addc_u32 s11, s11, 0
  s_waitcnt vmcnt(19)
  global_load_lds_dwordx4 v12, s[10:11] offset:0 nt
  s_waitcnt vmcnt(19)
  global_load_lds_dwordx4 v13, s[10:11] offset:1024 nt
  s_waitcnt vmcnt(19)
  global_load_lds_dwordx4 v14, s[10:11] offset:2048 nt
  s_waitcnt vmcnt(19)
  global_load_lds_dwordx4 v15, s[10:11] offset:3072 nt
  s_mov_b32 m0, 69632
  s_nop 0
  s_waitcnt vmcnt(19)
  global_load_lds_dwordx4 v20, s[22:23] offset:0 nt
  s_waitcnt vmcnt(19)
  global_load_lds_dwordx4 v21, s[22:23] offset:1024 nt
  s_waitcnt vmcnt(19)
  global_load_lds_dwordx4 v22, s[22:23] offset:2048 nt
  v_mov_b32 v28, 12
  s_waitcnt vmcnt(19)
  ds_write_b32 v7, v28 offset:8
  global_load_lds_dwordx4 v23, s[22:23] offset:3072 nt
  s_mov_b32 m0, 53248
  s_add_u32 s10, s10, 131072
  s_addc_u32 s11, s11, 0
  s_waitcnt vmcnt(19)
  global_load_lds_dwordx4 v12, s[10:11] offset:0 nt
  s_waitcnt vmcnt(19)
  global_load_lds_dwordx4 v13, s[10:11] offset:1024 nt
  s_waitcnt vmcnt(19)
  global_load_lds_dwordx4 v14, s[10:11] offset:2048 nt
  v_mov_b32 v28, 16
  s_waitcnt vmcnt(19)
  ds_write_b32 v7, v28 offset:8
  global_load_lds_dwordx4 v15, s[10:11] offset:3072 nt
  s_mov_b32 m0, 57344
  s_add_u32 s10, s10, 131072
  s_addc_u32 s11, s11, 0
  s_waitcnt vmcnt(19)
  global_load_lds_dwordx4 v12, s[10:11] offset:0 nt
  s_waitcnt vmcnt(19)
  global_load_lds_dwordx4 v13, s[10:11] offset:1024 nt
  s_waitcnt vmcnt(19)
  global_load_lds_dwordx4 v14, s[10:11] offset:2048 nt
  s_waitcnt vmcnt(19)
  global_load_lds_dwordx4 v15, s[10:11] offset:3072 nt
  s_mov_b32 m0, 73728
  s_add_u32 s22, s22, 114688
  s_addc_u32 s23, s23, 0
  s_waitcnt vmcnt(19)
  global_load_lds_dwordx4 v20, s[22:23] offset:0 nt
  s_waitcnt vmcnt(19)
  global_load_lds_dwordx4 v21, s[22:23] offset:1024 nt
  s_waitcnt vmcnt(19)
  global_load_lds_dwordx4 v22, s[22:23] offset:2048 nt
  v_mov_b32 v28, 20
  s_waitcnt vmcnt(19)
  ds_write_b32 v7, v28 offset:8
  global_load_lds_dwordx4 v23, s[22:23] offset:3072 nt
  s_mov_b32 m0, 77824
  s_nop 0
  global_load_lds_dwordx4 v16, s[12:13] offset:0 nt
  global_load_lds_dwordx4 v17, s[12:13] offset:1024 nt
  global_load_lds_dwordx4 v18, s[12:13] offset:2048 nt
  global_load_lds_dwordx4 v19, s[12:13] offset:3072 nt
  s_mov_b32 m0, 81920
  s_add_u32 s12, s12, 131072
  s_addc_u32 s13, s13, 0
  s_waitcnt vmcnt(23)
  global_load_lds_dwordx4 v16, s[12:13] offset:0 nt
  s_waitcnt vmcnt(23)
  global_load_lds_dwordx4 v17, s[12:13] offset:1024 nt
  s_waitcnt vmcnt(23)
  global_load_lds_dwordx4 v18, s[12:13] offset:2048 nt
  v_mov_b32 v28, 24
  s_waitcnt vmcnt(23)
  ds_write_b32 v7, v28 offset:8
  global_load_lds_dwordx4 v19, s[12:13] offset:3072 nt
  s_mov_b32 m0, 110592
  s_nop 0
  s_waitcnt vmcnt(23)
  global_load_lds_dwordx4 v24, s[24:25] offset:0 nt
  s_waitcnt vmcnt(23)
  global_load_lds_dwordx4 v25, s[24:25] offset:1024 nt
  s_waitcnt vmcnt(23)
  global_load_lds_dwordx4 v26, s[24:25] offset:2048 nt
  s_waitcnt vmcnt(23)
  s_branch L_L3
  .fill ((4096 - (. - recurrent_scan__sliding_block_cached__geglu_ffn__decode_kernel) % 4096) % 4096) / 4, 4, 0xbf800000
T_L3:
  s_branch L_W2
L_L3:
  global_load_lds_dwordx4 v27, s[24:25] offset:3072 nt
  s_mov_b32 m0, 86016
  s_add_u32 s12, s12, 131072
  s_addc_u32 s13, s13, 0
  s_waitcnt vmcnt(23)
  global_load_lds_dwordx4 v16, s[12:13] offset:0 nt
  s_waitcnt vmcnt(23)
  global_load_lds_dwordx4 v17, s[12:13] offset:1024 nt
  s_waitcnt vmcnt(23)
  global_load_lds_dwordx4 v18, s[12:13] offset:2048 nt
  v_mov_b32 v28, 28
  s_waitcnt vmcnt(23)
  ds_write_b32 v7, v28 offset:8
  global_load_lds_dwordx4 v19, s[12:13] offset:3072 nt
  s_mov_b32 m0, 90112
  s_add_u32 s12, s12, 131072
  s_addc_u32 s13, s13, 0
  s_waitcnt vmcnt(23)
  global_load_lds_dwordx4 v16, s[12:13] offset:0 nt
  s_waitcnt vmcnt(23)
  global_load_lds_dwordx4 v17, s[12:13] offset:1024 nt
  s_waitcnt vmcnt(23)
  global_load_lds_dwordx4 v18, s[12:13] offset:2048 nt
  v_mov_b32 v28, 32
  s_waitcnt vmcnt(23)
  ds_write_b32 v7, v28 offset:8
  global_load_lds_dwordx4 v19, s[12:13] offset:3072 nt
  s_mov_b32 m0, 114688
  s_add_u32 s24, s24, 32768
  s_addc_u32 s25, s25, 0
  s_waitcnt vmcnt(23)
  global_load_lds_dwordx4 v24, s[24:25] offset:0 nt
  s_waitcnt vmcnt(23)
  global_load_lds_dwordx4 v25, s[24:25] offset:1024 nt
  s_waitcnt vmcnt(23)
  global_load_lds_dwordx4 v26, s[24:25] offset:2048 nt
  v_mov_b32 v28, 16
  s_waitcnt vmcnt(23)
  ds_write_b32 v7, v28 offset:12
  global_load_lds_dwordx4 v27, s[24:25] offset:3072 nt
  s_mov_b32 m0, 94208
  s_add_u32 s12, s12, 131072
  s_addc_u32 s13, s13, 0
  s_waitcnt vmcnt(23)
  global_load_lds_dwordx4 v16, s[12:13] offset:0 nt
  s_waitcnt vmcnt(23)
  global_load_lds_dwordx4 v17, s[12:13] offset:1024 nt
  s_waitcnt vmcnt(23)
  global_load_lds_dwordx4 v18, s[12:13] offset:2048 nt
  s_waitcnt vmcnt(23)
  global_load_lds_dwordx4 v19, s[12:13] offset:3072 nt
  s_mov_b32 m0, 98304
  s_add_u32 s12, s12, 131072
  s_addc_u32 s13, s13, 0
  s_waitcnt vmcnt(23)
  global_load_lds_dwordx4 v16, s[12:13] offset:0 nt
  s_waitcnt vmcnt(23)
  global_load_lds_dwordx4 v17, s[12:13] offset:1024 nt
  s_waitcnt vmcnt(23)
  global_load_lds_dwordx4 v18, s[12:13] offset:2048 nt
  v_mov_b32 v28, 8
  s_waitcnt vmcnt(23)
  ds_write_b32 v7, v28 offset:16
  global_load_lds_dwordx4 v19, s[12:13] offset:3072 nt
  s_mov_b32 m0, 118784
  s_nop 0
  s_waitcnt vmcnt(23)
  global_load_lds_dwordx4 v24, s[16:17] offset:0 nt
  s_waitcnt vmcnt(23)
  global_load_lds_dwordx4 v25, s[16:17] offset:1024 nt
  s_waitcnt vmcnt(23)
  global_load_lds_dwordx4 v26, s[16:17] offset:2048 nt
  s_waitcnt vmcnt(23)
  global_load_lds_dwordx4 v27, s[16:17] offset:3072 nt
  s_mov_b32 m0, 102400
  s_add_u32 s12, s12, 131072
  s_addc_u32 s13, s13, 0
  s_waitcnt vmcnt(23)
  global_load_lds_dwordx4 v16, s[12:13] offset:0 nt
  s_waitcnt vmcnt(23)
  global_load_lds_dwordx4 v17, s[12:13] offset:1024 nt
  s_waitcnt vmcnt(23)
  global_load_lds_dwordx4 v18, s[12:13] offset:2048 nt
  s_waitcnt vmcnt(23)
  global_load_lds_dwordx4 v19, s[12:13] offset:3072 nt
  s_mov_b32 m0, 106496
  s_add_u32 s12, s12, 131072
  s_addc_u32 s13, s13, 0
  s_waitcnt vmcnt(23)
  global_load_lds_dwordx4 v16, s[12:13] offset:0 nt
  s_waitcnt vmcnt(23)
  global_load_lds_dwordx4 v17, s[12:13] offset:1024 nt
  s_waitcnt vmcnt(23)
  global_load_lds_dwordx4 v18, s[12:13] offset:2048 nt
  v_mov_b32 v28, 16
  s_waitcnt vmcnt(23)
  ds_write_b32 v7, v28 offset:16
  global_load_lds_dwordx4 v19, s[12:13] offset:3072 nt
  s_mov_b32 m0, 122880
  s_add_u32 s16, s16, 32768
  s_addc_u32 s17, s17, 0
  s_waitcnt vmcnt(23)
  global_load_lds_dwordx4 v24, s[16:17] offset:0 nt
  s_waitcnt vmcnt(23)
  global_load_lds_dwordx4 v25, s[16:17] offset:1024 nt
  s_waitcnt vmcnt(23)
  global_load_lds_dwordx4 v26, s[16:17] offset:2048 nt
  v_mov_b32 v28, 8
  s_waitcnt vmcnt(23)
  ds_write_b32 v7, v28 offset:20
  global_load_lds_dwordx4 v27, s[16:17] offset:3072 nt
  s_mov_b32 m0, 126976
  s_add_u32 s16, s16, 32768
  s_addc_u32 s17, s17, 0
  s_waitcnt vmcnt(23)
  global_load_lds_dwordx4 v24, s[16:17] offset:0 nt
  s_waitcnt vmcnt(23)
  global_load_lds_dwordx4 v25, s[16:17] offset:1024 nt
  s_waitcnt vmcnt(23)
  global_load_lds_dwordx4 v26, s[16:17] offset:2048 nt
  s_waitcnt vmcnt(23)
  global_load_lds_dwordx4 v27, s[16:17] offset:3072 nt
  s_mov_b32 m0, 131072
  s_add_u32 s16, s16, 32768
  s_addc_u32 s17, s17, 0
  s_waitcnt vmcnt(23)
  global_load_lds_dwordx4 v24, s[16:17] offset:0 nt
  s_waitcnt vmcnt(23)
  global_load_lds_dwordx4 v25, s[16:17] offset:1024 nt
  s_waitcnt vmcnt(23)
  global_load_lds_dwordx4 v26, s[16:17] offset:2048 nt
  v_mov_b32 v28, 24
  s_waitcnt vmcnt(23)
  ds_write_b32 v7, v28 offset:16
  global_load_lds_dwordx4 v27, s[16:17] offset:3072 nt
  v_mov_b32 v28, 4
  s_waitcnt vmcnt(20)
  ds_write_b32 v7, v28 offset:24
  v_mov_b32 v28, 32
  s_waitcnt vmcnt(12)
  ds_write_b32 v7, v28 offset:16
  v_mov_b32 v28, 8
  s_waitcnt vmcnt(8)
  ds_write_b32 v7, v28 offset:24
  v_mov_b32 v28, 12
  s_waitcnt vmcnt(4)
  ds_write_b32 v7, v28 offset:24
  v_mov_b32 v28, 16
  s_waitcnt vmcnt(0)
  ds_write_b32 v7, v28 offset:24
  s_mov_b64 exec, -1
  s_endpgm
T_G:
  s_branch T_L3
L_G:
  s_cmp_eq_u32 s4, 0
  s_cselect_b32 s44, 28, 16
  s_cselect_b32 s45, 36, 24
  s_branch L_sent_13
L_spin_12:
  s_sleep 1
L_sent_13:
  ds_read_b32 v12, v7 offset:8
  s_waitcnt lgkmcnt(0)
  v_readfirstlane_b32 s7, v12
  s_nop 0
  s_cmp_lt_u32 s7, s44
  s_cbranch_scc1 L_spin_12
  global_load_dwordx4 v[24:27], v22, s[32:33] offset:0 sc1
  global_load_dwordx4 v[28:31], v22, s[32:33] offset:1024 sc1
  global_load_dwordx4 v[32:35], v22, s[32:33] offset:2048 sc1
  global_load_dwordx4 v[36:39], v22, s[32:33] offset:3072 sc1
  global_load_dwordx4 v[40:43], v23, s[32:33] offset:0 sc1
  global_load_dwordx4 v[44:47], v23, s[32:33] offset:1024 sc1
  global_load_dwordx4 v[48:51], v23, s[32:33] offset:2048 sc1
  global_load_dwordx4 v[52:55], v23, s[32:33] offset:3072 sc1
  global_load_dword v120, v5, s[32:33] sc1
  s_branch L_sent_15
L_spin_14:
  s_sleep 1
L_sent_15:
  ds_read_b32 v12, v7 offset:8
  s_waitcnt lgkmcnt(0)
  v_readfirstlane_b32 s7, v12
  s_nop 0
  s_cmp_lt_u32 s7, s45
  s_cbranch_scc1 L_spin_14
  global_load_dwordx4 v[56:59], v22, s[32:33] offset:0 sc1
  global_load_dwordx4 v[60:63], v22, s[32:33] offset:1024 sc1
  global_load_dwordx4 v[64:67], v22, s[32:33] offset:2048 sc1
  global_load_dwordx4 v[68:71], v22, s[32:33] offset:3072 sc1
  global_load_dwordx4 v[72:75], v23, s[32:33] offset:0 sc1
  global_load_dwordx4 v[76:79], v23, s[32:33] offset:1024 sc1
  global_load_dwordx4 v[80:83], v23, s[32:33] offset:2048 sc1
  global_load_dwordx4 v[84:87], v23, s[32:33] offset:3072 sc1
  global_load_dword v121, v5, s[32:33] sc1
  s_mov_b32 s36, 0
L_qtop_16:
  s_waitcnt vmcnt(9)
  v_cmpx_eq_u32 vcc, s6, v27
  v_cmpx_eq_u32 vcc, s6, v31
  v_cmpx_eq_u32 vcc, s6, v35
  v_cmpx_eq_u32 vcc, s6, v39
  v_cmpx_eq_u32 vcc, s6, v43
  v_cmpx_eq_u32 vcc, s6, v47
  v_cmpx_eq_u32 vcc, s6, v51
  v_cmpx_eq_u32 vcc, s6, v55
  s_nop 0
  s_cmp_eq_u64 exec, -1
  s_mov_b64 exec, -1
  s_cbranch_scc1 L_qok_9
  global_load_dwordx4 v[24:27], v22, s[32:33] offset:0 sc1
  global_load_dwordx4 v[28:31], v22, s[32:33] offset:1024 sc1
  global_load_dwordx4 v[32:35], v22, s[32:33] offset:2048 sc1
  global_load_dwordx4 v[36:39], v22, s[32:33] offset:3072 sc1
  global_load_dwordx4 v[40:43], v23, s[32:33] offset:0 sc1
  global_load_dwordx4 v[44:47], v23, s[32:33] offset:1024 sc1
  global_load_dwordx4 v[48:51], v23, s[32:33] offset:2048 sc1
  global_load_dwordx4 v[52:55], v23, s[32:33] offset:3072 sc1
  global_load_dword v120, v5, s[32:33] sc1
  s_waitcnt vmcnt(9)
  v_cmpx_eq_u32 vcc, s6, v59
  v_cmpx_eq_u32 vcc, s6, v63
  v_cmpx_eq_u32 vcc, s6, v67
  v_cmpx_eq_u32 vcc, s6, v71
  v_cmpx_eq_u32 vcc, s6, v75
  v_cmpx_eq_u32 vcc, s6, v79
  v_cmpx_eq_u32 vcc, s6, v83
  v_cmpx_eq_u32 vcc, s6, v87
  s_nop 0
  s_cmp_eq_u64 exec, -1
  s_mov_b64 exec, -1
  s_cbranch_scc1 L_qok_10
  s_and_b32 s37, s36, 3
  s_cmp_eq_u32 s37, 3
  s_cbranch_scc1 L_qgl_17
  global_load_dwordx4 v[56:59], v22, s[32:33] offset:0 sc1
  global_load_dwordx4 v[60:63], v22, s[32:33] offset:1024 sc1
  global_load_dwordx4 v[64:67], v22, s[32:33] offset:2048 sc1
  global_load_dwordx4 v[68:71], v22, s[32:33] offset:3072 sc1
  global_load_dwordx4 v[72:75], v23, s[32:33] offset:0 sc1
  global_load_dwordx4 v[76:79], v23, s[32:33] offset:1024 sc1
  global_load_dwordx4 v[80:83], v23, s[32:33] offset:2048 sc1
  global_load_dwordx4 v[84:87], v23, s[32:33] offset:3072 sc1
  s_branch L_qck_18
L_qgl_17:
  global_load_dwordx4 v[56:59], v22, s[30:31] offset:0 sc1
  global_load_dwordx4 v[60:63], v22, s[30:31] offset:1024 sc1
  global_load_dwordx4 v[64:67], v22, s[30:31] offset:2048 sc1
  global_load_dwordx4 v[68:71], v22, s[30:31] offset:3072 sc1
  global_load_dwordx4 v[72:75], v23, s[30:31] offset:0 sc1
  global_load_dwordx4 v[76:79], v23, s[30:31] offset:1024 sc1
  global_load_dwordx4 v[80:83], v23, s[30:31] offset:2048 sc1
  global_load_dwordx4 v[84:87], v23, s[30:31] offset:3072 sc1
L_qck_18:
  global_load_dword v121, v5, s[32:33] sc1
  s_cmp_lg_u32 s36, 1
  s_cbranch_scc1 L_lz_19
  s_mov_b64 exec, 0xffff
  global_store_dwordx4 v123, v[124:127], s[30:31] sc1
  s_mov_b64 exec, -1
  s_waitcnt vmcnt(0)
L_lz_19:
  s_add_u32 s36, s36, 1
  s_cmp_lt_u32 s36, 20000
  s_cbranch_scc1 L_qtop_16
  s_waitcnt vmcnt(0)
L_qok_9:
  v_cmp_eq_u32 vcc, s48, v120
  v_perm_b32 v27, v24, v25, s55
  v_perm_b32 v31, v28, v29, s55
  v_perm_b32 v35, v32, v33, s55
  v_perm_b32 v39, v36, v37, s55
  v_perm_b32 v43, v40, v41, s55
  v_perm_b32 v47, v44, v45, s55
  v_perm_b32 v51, v48, v49, s55
  v_perm_b32 v55, v52, v53, s55
  v_perm_b32 v27, v27, v26, s56
  v_perm_b32 v31, v31, v30, s56
  v_perm_b32 v35, v35, v34, s56
  v_perm_b32 v39, v39, v38, s56
  v_perm_b32 v43, v43, v42, s56
  v_perm_b32 v47, v47, v46, s56
  v_perm_b32 v51, v51, v50, s56
  v_perm_b32 v55, v55, v54, s56
  v_pk_add_f32 v[8:9], v[24:25], v[32:33]
  v_pk_add_f32 v[16:17], v[40:41], v[48:49]
  v_pk_add_f32 v[10:11], v[26:27], v[34:35]
  v_pk_add_f32 v[18:19], v[42:43], v[50:51]
  v_pk_add_f32 v[12:13], v[28:29], v[36:37]
  v_pk_add_f32 v[20:21], v[44:45], v[52:53]
  v_pk_add_f32 v[14:15], v[30:31], v[38:39]
  v_pk_add_f32 v[22:23], v[46:47], v[54:55]
  s_branch L_qgot_11
L_qok_10:
  v_cmp_eq_u32 vcc, s48, v121
  v_perm_b32 v59, v56, v57, s55
  v_perm_b32 v63, v60, v61, s55
  v_perm_b32 v67, v64, v65, s55
  v_perm_b32 v71, v68, v69, s55
  v_perm_b32 v75, v72, v73, s55
  v_perm_b32 v79, v76, v77, s55
  v_perm_b32 v83, v80, v81, s55
  v_perm_b32 v87, v84, v85, s55
  v_perm_b32 v59, v59, v58, s56
  v_perm_b32 v63, v63, v62, s56
  v_perm_b32 v67, v67, v66, s56
  v_perm_b32 v71, v71, v70, s56
  v_perm_b32 v75, v75, v74, s56
  v_perm_b32 v79, v79, v78, s56
  v_perm_b32 v83, v83, v82, s56
  v_perm_b32 v87, v87, v86, s56
  v_pk_add_f32 v[8:9], v[56:57], v[64:65]
  v_pk_add_f32 v[16:17], v[72:73], v[80:81]
  v_pk_add_f32 v[10:11], v[58:59], v[66:67]
  v_pk_add_f32 v[18:19], v[74:75], v[82:83]
  v_pk_add_f32 v[12:13], v[60:61], v[68:69]
  v_pk_add_f32 v[20:21], v[76:77], v[84:85]
  v_pk_add_f32 v[14:15], v[62:63], v[70:71]
  v_pk_add_f32 v[22:23], v[78:79], v[86:87]
L_qgot_11:
  v_pk_add_f32 v[8:9], v[8:9], v[16:17]
  v_pk_add_f32 v[10:11], v[10:11], v[18:19]
  v_pk_add_f32 v[12:13], v[12:13], v[20:21]
  v_pk_add_f32 v[14:15], v[14:15], v[22:23]
  s_cmp_eq_u64 vcc, -1
  s_cselect_b32 s40, 1, 2
  v_cvt_pk_bf16_f32 v8, v8, v9
  v_cvt_pk_bf16_f32 v10, v10, v11
  v_cvt_pk_bf16_f32 v12, v12, v13
  v_cvt_pk_bf16_f32 v14, v14, v15
  v_mov_b32 v16, s6
  v_mov_b32 v17, s40
  ds_write_b16 v2, v8 offset:256
  ds_write_b16_d16_hi v2, v8 offset:288
  ds_write_b16 v2, v10 offset:320
  ds_write_b16_d16_hi v2, v10 offset:352
  ds_write_b16 v2, v12 offset:896
  ds_write_b16_d16_hi v2, v12 offset:928
  ds_write_b16 v2, v14 offset:960
  ds_write_b16_d16_hi v2, v14 offset:992
  ds_write_b64 v7, v[16:17] offset:32
  s_cmp_eq_u32 s40, 1
  s_cbranch_scc1 L_lz_20
  s_mov_b64 exec, 0xffff
  global_store_dwordx4 v123, v[124:127], s[30:31] sc1
  s_mov_b64 exec, -1
L_lz_20:
  s_endpgm
T_LL:
  s_branch L_bar
L_LL:
  s_mov_b32 m0, 36864
  s_add_u32 s10, s10, 131072
  s_addc_u32 s11, s11, 0
  v_mov_b32 v28, 1
  s_waitcnt vmcnt(24)
  ds_write_b32 v7, v28 offset:56
  s_waitcnt vmcnt(23)
  global_load_lds_dwordx4 v12, s[10:11] offset:0 nt
  s_waitcnt vmcnt(23)
  global_load_lds_dwordx4 v13, s[10:11] offset:1024 nt
  s_waitcnt vmcnt(23)
  global_load_lds_dwordx4 v14, s[10:11] offset:2048 nt
  s_waitcnt vmcnt(23)
  global_load_lds_dwordx4 v15, s[10:11] offset:3072 nt
  s_mov_b32 m0, 40960
  s_add_u32 s10, s10, 131072
  s_addc_u32 s11, s11, 0
  s_waitcnt vmcnt(23)
  global_load_lds_dwordx4 v12, s[10:11] offset:0 nt
  s_waitcnt vmcnt(23)
  global_load_lds_dwordx4 v13, s[10:11] offset:1024 nt
  s_waitcnt vmcnt(23)
  global_load_lds_dwordx4 v14, s[10:11] offset:2048 nt
  v_mov_b32 v28, 8
  s_waitcnt vmcnt(23)
  ds_write_b32 v7, v28 offset:60
  global_load_lds_dwordx4 v15, s[10:11] offset:3072 nt
  s_mov_b32 m0, 45056
  s_add_u32 s10, s10, 131072
  s_addc_u32 s11, s11, 0
  s_waitcnt vmcnt(23)
  global_load_lds_dwordx4 v12, s[10:11] offset:0 nt
  s_waitcnt vmcnt(23)
  global_load_lds_dwordx4 v13, s[10:11] offset:1024 nt
  s_waitcnt vmcnt(23)
  global_load_lds_dwordx4 v14, s[10:11] offset:2048 nt
  v_mov_b32 v28, 12
  s_waitcnt vmcnt(23)
  ds_write_b32 v7, v28 offset:60
  global_load_lds_dwordx4 v15, s[10:11] offset:3072 nt
  s_mov_b32 m0, 49152
  s_add_u32 s10, s10, 131072
  s_addc_u32 s11, s11, 0
  s_waitcnt vmcnt(23)
  global_load_lds_dwordx4 v12, s[10:11] offset:0 nt
  s_waitcnt vmcnt(23)
  global_load_lds_dwordx4 v13, s[10:11] offset:1024 nt
  s_waitcnt vmcnt(23)
  global_load_lds_dwordx4 v14, s[10:11] offset:2048 nt
  v_mov_b32 v28, 16
  s_waitcnt vmcnt(23)
  ds_write_b32 v7, v28 offset:60
  global_load_lds_dwordx4 v15, s[10:11] offset:3072 nt
  s_mov_b32 m0, 53248
  s_add_u32 s10, s10, 131072
  s_addc_u32 s11, s11, 0
  s_waitcnt vmcnt(23)
  global_load_lds_dwordx4 v12, s[10:11] offset:0 nt
  s_waitcnt vmcnt(23)
  global_load_lds_dwordx4 v13, s[10:11] offset:1024 nt
  s_waitcnt vmcnt(23)
  global_load_lds_dwordx4 v14, s[10:11] offset:2048 nt
  v_mov_b32 v28, 4
  s_waitcnt vmcnt(23)
  ds_write_b32 v7, v28 offset:8
  global_load_lds_dwordx4 v15, s[10:11] offset:3072 nt
  s_mov_b32 m0, 57344
  s_add_u32 s10, s10, 131072
  s_addc_u32 s11, s11, 0
  s_waitcnt vmcnt(23)
  global_load_lds_dwordx4 v12, s[10:11] offset:0 nt
  s_waitcnt vmcnt(23)
  global_load_lds_dwordx4 v13, s[10:11] offset:1024 nt
  s_waitcnt vmcnt(23)
  global_load_lds_dwordx4 v14, s[10:11] offset:2048 nt
  v_mov_b32 v28, 8
  s_waitcnt vmcnt(23)
  ds_write_b32 v7, v28 offset:8
  global_load_lds_dwordx4 v15, s[10:11] offset:3072 nt
  s_mov_b32 m0, 77824
  s_nop 0
  s_waitcnt vmcnt(23)
  global_load_lds_dwordx4 v16, s[12:13] offset:0 nt
  s_waitcnt vmcnt(23)
  global_load_lds_dwordx4 v17, s[12:13] offset:1024 nt
  s_waitcnt vmcnt(23)
  global_load_lds_dwordx4 v18, s[12:13] offset:2048 nt
  v_mov_b32 v28, 12
  s_waitcnt vmcnt(23)
  ds_write_b32 v7, v28 offset:8
  global_load_lds_dwordx4 v19, s[12:13] offset:3072 nt
  s_mov_b32 m0, 81920
  s_add_u32 s12, s12, 131072
  s_addc_u32 s13, s13, 0
  s_waitcnt vmcnt(23)
  global_load_lds_dwordx4 v16, s[12:13] offset:0 nt
  s_waitcnt vmcnt(23)
  global_load_lds_dwordx4 v17, s[12:13] offset:1024 nt
  s_waitcnt vmcnt(23)
  global_load_lds_dwordx4 v18, s[12:13] offset:2048 nt
  v_mov_b32 v28, 16
  s_waitcnt vmcnt(23)
  ds_write_b32 v7, v28 offset:8
  global_load_lds_dwordx4 v19, s[12:13] offset:3072 nt
  s_mov_b32 m0, 86016
  s_add_u32 s12, s12, 131072
  s_addc_u32 s13, s13, 0
  s_waitcnt vmcnt(23)
  global_load_lds_dwordx4 v16, s[12:13] offset:0 nt
  s_waitcnt vmcnt(23)
  global_load_lds_dwordx4 v17, s[12:13] offset:1024 nt
  s_waitcnt vmcnt(23)
  global_load_lds_dwordx4 v18, s[12:13] offset:2048 nt
  v_mov_b32 v28, 20
  s_waitcnt vmcnt(23)
  ds_write_b32 v7, v28 offset:8
  global_load_lds_dwordx4 v19, s[12:13] offset:3072 nt
  s_mov_b32 m0, 90112
  s_add_u32 s12, s12, 131072
  s_addc_u32 s13, s13, 0
  s_waitcnt vmcnt(23)
  global_load_lds_dwordx4 v16, s[12:13] offset:0 nt
  s_waitcnt vmcnt(23)
  global_load_lds_dwordx4 v17, s[12:13] offset:1024 nt
  s_waitcnt vmcnt(23)
  global_load_lds_dwordx4 v18, s[12:13] offset:2048 nt
  v_mov_b32 v28, 24
  s_waitcnt vmcnt(23)
  ds_write_b32 v7, v28 offset:8
  global_load_lds_dwordx4 v19, s[12:13] offset:3072 nt
  s_mov_b32 m0, 94208
  s_add_u32 s12, s12, 131072
  s_addc_u32 s13, s13, 0
  s_waitcnt vmcnt(23)
  global_load_lds_dwordx4 v16, s[12:13] offset:0 nt
  s_waitcnt vmcnt(23)
  global_load_lds_dwordx4 v17, s[12:13] offset:1024 nt
  s_waitcnt vmcnt(23)
  global_load_lds_dwordx4 v18, s[12:13] offset:2048 nt
  v_mov_b32 v28, 28
  s_waitcnt vmcnt(23)
  ds_write_b32 v7, v28 offset:8
  global_load_lds_dwordx4 v19, s[12:13] offset:3072 nt
  s_mov_b32 m0, 98304
  s_add_u32 s12, s12, 131072
  s_addc_u32 s13, s13, 0
  s_waitcnt vmcnt(23)
  global_load_lds_dwordx4 v16, s[12:13] offset:0 nt
  s_waitcnt vmcnt(23)
  global_load_lds_dwordx4 v17, s[12:13] offset:1024 nt
  s_waitcnt vmcnt(23)
  global_load_lds_dwordx4 v18, s[12:13] offset:2048 nt
  v_mov_b32 v28, 32
  s_waitcnt vmcnt(23)
  ds_write_b32 v7, v28 offset:8
  global_load_lds_dwordx4 v19, s[12:13] offset:3072 nt
  s_mov_b32 m0, 118784
  s_nop 0
  s_waitcnt vmcnt(23)
  global_load_lds_dwordx4 v24, s[16:17] offset:0 nt
  s_waitcnt vmcnt(23)
  global_load_lds_dwordx4 v25, s[16:17] offset:1024 nt
  s_waitcnt vmcnt(23)
  global_load_lds_dwordx4 v26, s[16:17] offset:2048 nt
  v_mov_b32 v28, 36
  s_waitcnt vmcnt(23)
  ds_write_b32 v7, v28 offset:8
  global_load_lds_dwordx4 v27, s[16:17] offset:3072 nt
  s_mov_b32 m0, 102400
  s_add_u32 s12, s12, 131072
  s_addc_u32 s13, s13, 0
  s_waitcnt vmcnt(23)
  global_load_lds_dwordx4 v16, s[12:13] offset:0 nt
  s_waitcnt vmcnt(23)
  global_load_lds_dwordx4 v17, s[12:13] offset:1024 nt
  s_waitcnt vmcnt(23)
  global_load_lds_dwordx4 v18, s[12:13] offset:2048 nt
  v_mov_b32 v28, 8
  s_waitcnt vmcnt(23)
  ds_write_b32 v7, v28 offset:16
  global_load_lds_dwordx4 v19, s[12:13] offset:3072 nt
  s_mov_b32 m0, 106496
  s_add_u32 s12, s12, 131072
  s_addc_u32 s13, s13, 0
  s_waitcnt vmcnt(23)
  global_load_lds_dwordx4 v16, s[12:13] offset:0 nt
  s_waitcnt vmcnt(23)
  global_load_lds_dwordx4 v17, s[12:13] offset:1024 nt
  s_waitcnt vmcnt(23)
  global_load_lds_dwordx4 v18, s[12:13] offset:2048 nt
  s_waitcnt vmcnt(23)
  global_load_lds_dwordx4 v19, s[12:13] offset:3072 nt
  s_mov_b32 m0, 122880
  s_add_u32 s16, s16, 32768
  s_addc_u32 s17, s17, 0
  s_waitcnt vmcnt(23)
  global_load_lds_dwordx4 v24, s[16:17] offset:0 nt
  s_waitcnt vmcnt(23)
  global_load_lds_dwordx4 v25, s[16:17] offset:1024 nt
  s_waitcnt vmcnt(23)
  global_load_lds_dwordx4 v26, s[16:17] offset:2048 nt
  v_mov_b32 v28, 16
  s_waitcnt vmcnt(23)
  ds_write_b32 v7, v28 offset:16
  global_load_lds_dwordx4 v27, s[16:17] offset:3072 nt
  s_mov_b32 m0, 126976
  s_add_u32 s16, s16, 32768
  s_addc_u32 s17, s17, 0
  s_waitcnt vmcnt(23)
  global_load_lds_dwordx4 v24, s[16:17] offset:0 nt
  s_waitcnt vmcnt(23)
  global_load_lds_dwordx4 v25, s[16:17] offset:1024 nt
  s_waitcnt vmcnt(23)
  global_load_lds_dwordx4 v26, s[16:17] offset:2048 nt
  s_waitcnt vmcnt(23)
  global_load_lds_dwordx4 v27, s[16:17] offset:3072 nt
  s_mov_b32 m0, 131072
  s_add_u32 s16, s16, 32768
  s_addc_u32 s17, s17, 0
  s_waitcnt vmcnt(23)
  global_load_lds_dwordx4 v24, s[16:17] offset:0 nt
  s_waitcnt vmcnt(23)
  global_load_lds_dwordx4 v25, s[16:17] offset:1024 nt
  s_waitcnt vmcnt(23)
  global_load_lds_dwordx4 v26, s[16:17] offset:2048 nt
  v_mov_b32 v28, 24
  s_waitcnt vmcnt(23)
  ds_write_b32 v7, v28 offset:16
  global_load_lds_dwordx4 v27, s[16:17] offset:3072 nt
  v_mov_b32 v28, 4
  s_waitcnt vmcnt(20)
  ds_write_b32 v7, v28 offset:24
  v_mov_b32 v28, 32
  s_waitcnt vmcnt(12)
  ds_write_b32 v7, v28 offset:16
  v_mov_b32 v28, 8
  s_waitcnt vmcnt(8)
  ds_write_b32 v7, v28 offset:24
  v_mov_b32 v28, 12
  s_waitcnt vmcnt(4)
  ds_write_b32 v7, v28 offset:24
  v_mov_b32 v28, 16
  s_waitcnt vmcnt(0)
  ds_write_b32 v7, v28 offset:24
L_LM:
  s_endpgm
  .fill ((4096 - (. - recurrent_scan__sliding_block_cached__geglu_ffn__decode_kernel) % 4096) % 4096) / 4, 4, 0xbf800000
L_A:
  s_setprio 1
  v_and_b32 v3, 15, v1
  v_lshrrev_b32 v4, 4, v1
  s_mov_b32 s52, 0x07060503
  s_mov_b32 s53, 0x07060502
  s_mov_b32 s54, 0x07060501
  s_mov_b32 s55, 0x04000c0c
  s_mov_b32 s56, 0x0706000c
  v_mov_b64 v[84:85], 0
  v_mov_b64 v[86:87], 0
  v_mov_b64 v[88:89], 0
  v_mov_b64 v[90:91], 0
  v_mov_b64 v[92:93], 0
  v_mov_b64 v[94:95], 0
  v_mov_b64 v[96:97], 0
  v_mov_b64 v[98:99], 0
  v_mov_b64 v[100:101], 0
  v_mov_b64 v[102:103], 0
  v_mov_b64 v[104:105], 0
  v_mov_b64 v[106:107], 0
  v_mov_b64 v[108:109], 0
  v_mov_b64 v[110:111], 0
  v_mov_b64 v[112:113], 0
  v_mov_b64 v[114:115], 0
  s_lshl_b32 s40, s46, 13
  s_add_u32 s40, s40, 28672
  v_xor_b32 v12, v3, v4
  v_lshlrev_b32 v12, 4, v12
  v_lshl_add_u32 v12, v3, 8, v12
  v_add_u32 v16, s40, v12
  v_xor_b32 v17, 64, v16
  v_xor_b32 v18, 128, v16
  v_xor_b32 v19, 192, v16
  v_lshrrev_b32 v12, 2, v1
  v_and_b32 v13, 7, v12
  s_lshl_b32 s40, s46, 1
  v_xor_b32 v13, s40, v13
  v_lshlrev_b32 v13, 5, v13
  v_lshl_add_u32 v13, v12, 8, v13
  v_and_b32 v14, 3, v1
  v_lshl_add_u32 v13, v14, 3, v13
  v_add_u32 v20, 77824, v13
  v_xor_b32 v21, 32, v20
  v_mul_u32_u24 v22, 320, v14
  v_lshl_add_u32 v22, v4, 4, v22
  v_lshlrev_b32 v124, 6, v14
  v_lshl_add_u32 v124, v4, 4, v124
  s_lshl_b32 s40, s46, 8
  v_add_u32 v23, s40, v124
  v_and_b32 v15, 12, v1
  v_add_u32 v23, v23, v15
  s_mov_b32 s60, 0xf0f0f0f0
  s_mov_b32 s61, s60
  s_mov_b32 s62, 0xff00ff00
  s_mov_b32 s63, s62
  s_mov_b32 s50, 0x41ddce9e
  v_lshlrev_b32 v125, 3, v14
  s_lshl_b32 s40, s46, 5
  v_add_u32 v126, s40, v125
  s_lshl_b32 s40, s4, 17
  s_add_u32 s40, s40, 1048576
  v_bfe_u32 v13, v1, 2, 1
  s_lshl_b32 s41, s5, 7
  s_lshl_b32 s42, s46, 12
  s_add_u32 s41, s41, s42
  s_add_u32 s41, s41, s40
  v_lshlrev_b32 v12, 15, v14
  v_lshl_add_u32 v127, v13, 6, v12
  v_lshl_add_u32 v127, v4, 4, v127
  v_add_u32 v127, s41, v127
  s_and_b32 s41, s5, 7
  s_lshr_b32 s42, s5, 3
  s_lshl2_add_u32 s41, s41, s42
  s_lshl4_add_u32 s41, s41, s40
  s_add_u32 s41, s41, 16384
  v_add_u32 v5, s41, v12
  s_mov_b32 s45, 0x3db504f3
  s_mov_b32 s47, 0x3fb8aa3b
  s_lshl_b32 s57, s46, 3
  s_add_u32 s57, s57, 8
  s_lshl_b64 s[58:59], 1, s46
  s_waitcnt lgkmcnt(0)
  s_add_u32 s32, s30, 4194304
  s_addc_u32 s33, s31, 0
  s_branch L_sent_44
L_spin_43:
  s_sleep 2
L_sent_44:
  ds_read_b32 v12, v7 offset:8
  s_waitcnt lgkmcnt(0)
  v_readfirstlane_b32 s7, v12
  s_nop 0
  s_cmp_lt_u32 s7, s57
  s_cbranch_scc1 L_spin_43
  ds_read_b128 v[24:27], v16 offset:0
  ds_read_b128 v[28:31], v17 offset:0
  ds_read_b128 v[32:35], v18 offset:0
  ds_read_b128 v[36:39], v19 offset:0
  ds_read_b128 v[40:43], v16 offset:4096
  ds_read_b128 v[44:47], v17 offset:4096
  ds_read_b128 v[48:51], v18 offset:4096
  ds_read_b128 v[52:55], v19 offset:4096
  s_setprio 2
  s_branch L_aqe_46
L_aq_45:
  s_sleep 1
L_aqe_46:
  ds_read_b64 v[12:13], v7 offset:32
  ds_read_b128 v[56:59], v22 offset:256
  ds_read_b128 v[60:63], v22 offset:320
  ds_read_b128 v[64:67], v22 offset:384
  ds_read_b128 v[68:71], v22 offset:448
  s_waitcnt lgkmcnt(0)
  v_readfirstlane_b32 s6, v12
  v_readfirstlane_b32 s48, v13
  s_cmp_eq_u32 s6, 0
  s_cbranch_scc1 L_aq_45
  v_mfma_f32_16x16x32_bf16 v[72:75], v[24:27], v[56:59], 0
  v_mfma_f32_16x16x32_bf16 v[76:79], v[40:43], v[56:59], 0
  v_mfma_f32_16x16x32_bf16 v[72:75], v[28:31], v[60:63], v[72:75]
  v_mfma_f32_16x16x32_bf16 v[76:79], v[44:47], v[60:63], v[76:79]
  v_mfma_f32_16x16x32_bf16 v[72:75], v[32:35], v[64:67], v[72:75]
  v_mfma_f32_16x16x32_bf16 v[76:79], v[48:51], v[64:67], v[76:79]
  v_mfma_f32_16x16x32_bf16 v[72:75], v[36:39], v[68:71], v[72:75]
  v_mfma_f32_16x16x32_bf16 v[76:79], v[52:55], v[68:71], v[76:79]
  v_mov_b32 v14, 0
  ds_read_b32 v81, v7 offset:16
  ds_read_b64_tr_b16 v[24:25], v20 offset:0
  ds_read_b64_tr_b16 v[26:27], v20 offset:4096
  ds_read_b64_tr_b16 v[28:29], v21 offset:0
  ds_read_b64_tr_b16 v[30:31], v21 offset:4096
  ds_read_b64_tr_b16 v[32:33], v20 offset:8192
  v_cvt_pk_bf16_f32 v8, v72, v73
  v_cvt_pk_bf16_f32 v9, v74, v75
  v_cvt_pk_bf16_f32 v10, v76, v77
  v_cvt_pk_bf16_f32 v11, v78, v79
  v_cndmask_b32 v8, v8, v9, s[60:61]
  v_cndmask_b32 v10, v10, v11, s[60:61]
  v_cndmask_b32 v8, v8, v10, s[62:63]
  v_lshlrev_b32 v72, 16, v8
  v_and_b32 v73, 0xffff0000, v8
  v_mul_f32 v72, s45, v72
  v_mul_f32 v73, s45, v73
  v_cvt_pk_bf16_f32 v8, v72, v73
  v_lshlrev_b32 v72, 16, v8
  v_and_b32 v73, 0xffff0000, v8
  v_max_f32 v12, |v72|, |v73|
  v_mul_f32 v74, s47, v72
  v_cmp_lt_f32 vcc, s50, v12
  v_mul_f32 v75, s47, v73
  s_cbranch_vccnz L_aslow
L_aexp:
  v_exp_f32 v74, v74
  v_exp_f32 v75, v75
  ds_read_b64_tr_b16 v[34:35], v20 offset:12288
  v_add_f32 v15, v74, v75
  v_cvt_pk_bf16_f32 v80, v74, v75
  ds_write_b32 v23, v80 offset:4096
  v_add_f32_dpp v15, v15, v15 row_ror:4 row_mask:0xf bank_mask:0xf
  ds_read_b64_tr_b16 v[36:37], v21 offset:8192
  ds_read_b64_tr_b16 v[38:39], v21 offset:12288
  v_add_f32_dpp v15, v15, v15 row_ror:8 row_mask:0xf bank_mask:0xf
  v_mov_b32 v13, v15
  ds_read_b64_tr_b16 v[40:41], v20 offset:16384
  ds_read_b64_tr_b16 v[42:43], v20 offset:20480
  v_permlane16_swap_b32 v15, v13
  v_add_f32 v15, v15, v13
  v_mov_b32 v13, v15
  ds_read_b64_tr_b16 v[44:45], v21 offset:16384
  ds_read_b64_tr_b16 v[46:47], v21 offset:20480
  v_permlane32_swap_b32 v15, v13
  v_add_f32 v15, v15, v13
  v_mov_b32 v12, 1
  s_mov_b64 exec, 15
  ds_write_b64 v126, v[14:15] offset:5120
  s_mov_b64 exec, 1
  ds_add_u32 v7, v12 offset:28
L_ap_47:
  s_mov_b64 exec, -1
  ds_read_b32 v13, v7 offset:28
  ds_read_b64 v[116:117], v125 offset:5120
  ds_read_b64 v[118:119], v125 offset:5152
  ds_read_b64 v[120:121], v125 offset:5184
  ds_read_b64 v[122:123], v125 offset:5216
  s_mov_b32 exec_lo, 983055
  s_mov_b32 exec_hi, 983055
  ds_read_b128 v[84:87], v124 offset:4096
  ds_read_b128 v[88:91], v124 offset:4352
  ds_read_b128 v[92:95], v124 offset:4608
  ds_read_b128 v[96:99], v124 offset:4864
  s_mov_b32 exec_lo, 15728880
  s_mov_b32 exec_hi, 15728880
  ds_read_b128 v[100:103], v124 offset:4096
  ds_read_b128 v[104:107], v124 offset:4352
  ds_read_b128 v[108:111], v124 offset:4608
  ds_read_b128 v[112:115], v124 offset:4864
  s_waitcnt lgkmcnt(8)
  v_readfirstlane_b32 s7, v13
  v_readfirstlane_b32 s49, v81
  s_cmp_lt_u32 s7, 4
  s_cbranch_scc1 L_ap_47
  s_mov_b64 exec, -1
  s_cmp_lt_u32 s49, 24
  s_cbranch_scc1 L_anov
  s_setprio 3
  s_waitcnt lgkmcnt(7)
  v_mfma_f32_16x16x32_bf16 v[56:59], v[24:27], v[84:87], 0
  s_waitcnt lgkmcnt(6)
  v_mfma_f32_16x16x32_bf16 v[60:63], v[32:35], v[88:91], 0
  s_waitcnt lgkmcnt(5)
  v_mfma_f32_16x16x32_bf16 v[64:67], v[40:43], v[92:95], 0
  s_waitcnt lgkmcnt(3)
  v_mfma_f32_16x16x32_bf16 v[56:59], v[28:31], v[100:103], v[56:59]
  s_waitcnt lgkmcnt(2)
  v_mfma_f32_16x16x32_bf16 v[60:63], v[36:39], v[104:107], v[60:63]
  s_waitcnt lgkmcnt(1)
  v_mfma_f32_16x16x32_bf16 v[64:67], v[44:47], v[108:111], v[64:67]
  ds_read_b32 v13, v7 offset:16
  ds_read_b64_tr_b16 v[48:49], v20 offset:24576
  ds_read_b64_tr_b16 v[50:51], v20 offset:28672
  ds_read_b64_tr_b16 v[52:53], v21 offset:24576
  ds_read_b64_tr_b16 v[54:55], v21 offset:28672
L_anov:
  v_max3_f32 v8, v116, v118, v120
  v_mov_b32 v11, s6
  s_mov_b32 s44, 0x42200000
  v_max_f32 v8, v8, v122
  v_cmp_lt_f32 vcc, s44, |v8|
  s_nop 1
  v_cndmask_b32 v8, 0, v8, vcc
  v_sub_f32 v116, v116, v8
  v_sub_f32 v118, v118, v8
  v_sub_f32 v120, v120, v8
  v_sub_f32 v122, v122, v8
  v_exp_f32 v116, v116
  v_exp_f32 v118, v118
  v_exp_f32 v120, v120
  v_exp_f32 v122, v122
  v_mul_f32 v9, v116, v117
  v_fmac_f32 v9, v118, v119
  v_fmac_f32 v9, v120, v121
  v_fmac_f32 v9, v122, v123
  s_mov_b64 exec, s[58:59]
  global_store_dwordx4 v5, v[8:11], s[32:33]
  s_cmp_eq_u32 s48, 1
  s_cbranch_scc1 L_same_48
  global_store_dwordx4 v5, v[8:11], s[30:31] sc1
L_same_48:
  s_mov_b64 exec, -1
  s_cmp_ge_u32 s49, 24
  s_cbranch_scc1 L_av3
  s_branch L_sent_50
T_Ap:
  s_branch L_W2
L_spin_49:
  s_sleep 2
L_sent_50:
  ds_read_b32 v12, v7 offset:16
  s_waitcnt lgkmcnt(0)
  v_readfirstlane_b32 s7, v12
  s_nop 0
  s_cmp_lt_u32 s7, 24
  s_cbranch_scc1 L_spin_49
  ds_read_b64_tr_b16 v[24:25], v20 offset:0
  ds_read_b64_tr_b16 v[26:27], v20 offset:4096
  ds_read_b64_tr_b16 v[28:29], v21 offset:0
  ds_read_b64_tr_b16 v[30:31], v21 offset:4096
  ds_read_b64_tr_b16 v[32:33], v20 offset:8192
  ds_read_b64_tr_b16 v[34:35], v20 offset:12288
  ds_read_b64_tr_b16 v[36:37], v21 offset:8192
  ds_read_b64_tr_b16 v[38:39], v21 offset:12288
  ds_read_b64_tr_b16 v[40:41], v20 offset:16384
  ds_read_b64_tr_b16 v[42:43], v20 offset:20480
  ds_read_b64_tr_b16 v[44:45], v21 offset:16384
  ds_read_b64_tr_b16 v[46:47], v21 offset:20480
  s_waitcnt lgkmcnt(10)
  v_mfma_f32_16x16x32_bf16 v[56:59], v[24:27], v[84:87], 0
  s_waitcnt lgkmcnt(6)
  v_mfma_f32_16x16x32_bf16 v[60:63], v[32:35], v[88:91], 0
  s_waitcnt lgkmcnt(2)
  v_mfma_f32_16x16x32_bf16 v[64:67], v[40:43], v[92:95], 0
  s_waitcnt lgkmcnt(0)
  v_mfma_f32_16x16x32_bf16 v[56:59], v[28:31], v[100:103], v[56:59]
  v_mfma_f32_16x16x32_bf16 v[60:63], v[36:39], v[104:107], v[60:63]
  v_mfma_f32_16x16x32_bf16 v[64:67], v[44:47], v[108:111], v[64:67]
  s_setprio 3
  ds_read_b32 v13, v7 offset:16
  ds_read_b64_tr_b16 v[48:49], v20 offset:24576
  ds_read_b64_tr_b16 v[50:51], v20 offset:28672
  ds_read_b64_tr_b16 v[52:53], v21 offset:24576
  ds_read_b64_tr_b16 v[54:55], v21 offset:28672
L_av3:
  v_mov_b32 v75, s6
  v_pk_mul_f32 v[76:77], v[56:57], v[116:117] op_sel_hi:[1,0]
  v_pk_mul_f32 v[78:79], v[58:59], v[116:117] op_sel_hi:[1,0]
  v_pk_fma_f32 v[76:77], v[60:61], v[118:119], v[76:77] op_sel_hi:[1,0,1]
  v_pk_fma_f32 v[78:79], v[62:63], v[118:119], v[78:79] op_sel_hi:[1,0,1]
  v_pk_fma_f32 v[76:77], v[64:65], v[120:121], v[76:77] op_sel_hi:[1,0,1]
  v_pk_fma_f32 v[78:79], v[66:67], v[120:121], v[78:79] op_sel_hi:[1,0,1]
  s_branch L_ave_52
L_av_51:
  ds_read_b32 v13, v7 offset:16
  ds_read_b64_tr_b16 v[48:49], v20 offset:24576
  ds_read_b64_tr_b16 v[50:51], v20 offset:28672
  ds_read_b64_tr_b16 v[52:53], v21 offset:24576
  ds_read_b64_tr_b16 v[54:55], v21 offset:28672
L_ave_52:
  s_waitcnt lgkmcnt(0)
  v_mfma_f32_16x16x32_bf16 v[68:71], v[48:51], v[96:99], 0
  v_readfirstlane_b32 s7, v13
  v_mfma_f32_16x16x32_bf16 v[68:71], v[52:55], v[112:115], v[68:71]
  s_cmp_lt_u32 s7, 32
  s_cbranch_scc1 L_av_51
  s_mov_b32 exec_lo, 16711935
  s_mov_b32 exec_hi, 16711935
  v_mov_b32 v12, 1
  s_nop 2
  v_pk_fma_f32 v[76:77], v[68:69], v[122:123], v[76:77] op_sel_hi:[1,0,1]
  v_pk_fma_f32 v[78:79], v[70:71], v[122:123], v[78:79] op_sel_hi:[1,0,1]
  v_perm_b32 v72, v76, v79, s52
  v_perm_b32 v73, v77, v79, s53
  v_perm_b32 v74, v78, v79, s54
  global_store_dwordx4 v127, v[72:75], s[32:33]
  s_cmp_eq_u32 s48, 1
  s_cbranch_scc1 L_same_53
  global_store_dwordx4 v127, v[72:75], s[30:31] sc1
L_same_53:
  s_mov_b64 exec, 1
  ds_add_u32 v7, v12 offset:48
  s_mov_b64 exec, -1
  s_endpgm
L_aslow:
  v_max_f32 v12, v72, v73
  s_nop 1
  v_max_f32_dpp v12, v12, v12 row_ror:4 row_mask:0xf bank_mask:0xf
  s_nop 1
  v_max_f32_dpp v12, v12, v12 row_ror:8 row_mask:0xf bank_mask:0xf
  v_mov_b32 v13, v12
  s_nop 1
  v_permlane16_swap_b32 v12, v13
  v_max_f32 v12, v12, v13
  v_mov_b32 v13, v12
  s_nop 1
  v_permlane32_swap_b32 v12, v13
  v_max_f32 v12, v12, v13
  v_mul_f32 v14, s47, v12
  v_fma_f32 v74, v72, s47, -v14
  v_fma_f32 v75, v73, s47, -v14
  s_branch L_aexp
T_F2:
  s_branch T_Z
L_F2:
  v_and_b32 v3, 15, v1
  v_lshrrev_b32 v4, 4, v1
  s_mov_b32 s52, 0x07060503
  s_mov_b32 s53, 0x07060502
  s_mov_b32 s54, 0x07060501
  s_mov_b32 s55, 0x04000c0c
  s_mov_b32 s56, 0x0706000c
  s_and_b32 s43, s5, 24
  s_add_u32 s44, s4, 7
  s_and_b32 s44, s44, 7
  s_lshr_b32 s62, s5, 3
  s_lshl2_add_u32 s44, s44, s62
  s_and_b32 s45, s5, 7
  s_add_u32 s32, s30, 4194304
  s_addc_u32 s33, s31, 0
  v_lshrrev_b32 v12, 2, v1
  v_lshlrev_b32 v12, 7, v12
  v_and_b32 v13, 3, v1
  v_lshl_add_u32 v12, v13, 3, v12
  v_bfe_u32 v13, v1, 3, 2
  v_lshl_add_u32 v12, v13, 5, v12
  v_add_u32 v16, 61440, v12
  v_xor_b32 v17, 32, v16
  v_xor_b32 v18, 64, v16
  v_xor_b32 v19, 96, v16
  v_mov_b64 v[88:89], 0
  v_mov_b64 v[90:91], 0
  v_mov_b64 v[92:93], 0
  v_mov_b64 v[94:95], 0
  v_mov_b64 v[96:97], 0
  v_mov_b64 v[98:99], 0
  v_mov_b64 v[100:101], 0
  v_mov_b64 v[102:103], 0
  s_lshl_b32 s41, s45, 7
  s_add_u32 s41, s41, 2048
  v_lshlrev_b32 v20, 4, v4
  v_add_u32 v20, s41, v20
  s_mov_b32 exec_lo, 983055
  s_mov_b32 exec_hi, 983055
  ds_read_b128 v[88:91], v20 offset:0
  ds_read_b128 v[92:95], v20 offset:64
  s_mov_b32 exec_lo, 15728880
  s_mov_b32 exec_hi, 15728880
  ds_read_b128 v[96:99], v20 offset:0
  ds_read_b128 v[100:103], v20 offset:64
  s_mov_b64 exec, -1
  s_lshl_b32 s40, s44, 12
  s_add_u32 s40, s40, 131072
  v_lshlrev_b32 v21, 4, v1
  v_add_u32 v21, s40, v21
  s_lshl_b32 s41, s45, 9
  v_add_u32 v22, s41, v21
  v_and_b32 v12, 1, v4
  v_lshlrev_b32 v23, 6, v12
  v_lshrrev_b32 v12, 2, v3
  v_lshl_add_u32 v23, v12, 4, v23
  v_and_b32 v12, 2, v4
  v_lshl_add_u32 v23, v12, 2, v23
  v_and_b32 v12, 3, v1
  v_lshl_add_u32 v23, v12, 1, v23
  v_mov_b32 v11, 0
  s_mov_b32 exec_hi, 0
  global_store_dwordx4 v22, v[8:11], s[32:33]
  s_mov_b32 exec_hi, -1
  s_nop 0
  v_mov_b32 v11, s6
  s_branch L_sent_22
L_spin_21:
  s_sleep 3
L_sent_22:
  ds_read_b32 v12, v7 offset:12
  s_waitcnt lgkmcnt(0)
  v_readfirstlane_b32 s7, v12
  s_nop 0
  s_cmp_lt_u32 s7, 16
  s_cbranch_scc1 L_spin_21
  s_setprio 1
  ds_read_b32 v13, v7 offset:36
  ds_read_b64_tr_b16 v[24:25], v16 offset:0
  ds_read_b64_tr_b16 v[26:27], v16 offset:2048
  ds_read_b64_tr_b16 v[28:29], v17 offset:0
  ds_read_b64_tr_b16 v[30:31], v17 offset:2048
  ds_read_b64_tr_b16 v[32:33], v18 offset:0
  ds_read_b64_tr_b16 v[34:35], v18 offset:2048
  ds_read_b64_tr_b16 v[36:37], v19 offset:0
  ds_read_b64_tr_b16 v[38:39], v19 offset:2048
  ds_read_b64_tr_b16 v[40:41], v16 offset:4096
  ds_read_b64_tr_b16 v[42:43], v16 offset:6144
  ds_read_b64_tr_b16 v[44:45], v17 offset:4096
  ds_read_b64_tr_b16 v[46:47], v17 offset:6144
  ds_read_b64_tr_b16 v[48:49], v18 offset:4096
  ds_read_b64_tr_b16 v[50:51], v18 offset:6144
  ds_read_b64_tr_b16 v[52:53], v19 offset:4096
  ds_read_b64_tr_b16 v[54:55], v19 offset:6144
  ds_read_b64_tr_b16 v[56:57], v16 offset:8192
  ds_read_b64_tr_b16 v[58:59], v16 offset:10240
  ds_read_b64_tr_b16 v[60:61], v17 offset:8192
  ds_read_b64_tr_b16 v[62:63], v17 offset:10240
  ds_read_b64_tr_b16 v[64:65], v18 offset:8192
  ds_read_b64_tr_b16 v[66:67], v18 offset:10240
  ds_read_b64_tr_b16 v[68:69], v19 offset:8192
  ds_read_b64_tr_b16 v[70:71], v19 offset:10240
  ds_read_b64_tr_b16 v[72:73], v16 offset:12288
  ds_read_b64_tr_b16 v[74:75], v16 offset:14336
  ds_read_b64_tr_b16 v[76:77], v17 offset:12288
  ds_read_b64_tr_b16 v[78:79], v17 offset:14336
  ds_read_b64_tr_b16 v[80:81], v18 offset:12288
  ds_read_b64_tr_b16 v[82:83], v18 offset:14336
  ds_read_b64_tr_b16 v[84:85], v19 offset:12288
  ds_read_b64_tr_b16 v[86:87], v19 offset:14336
  s_waitcnt lgkmcnt(15)
  v_mfma_f32_16x16x32_bf16 v[104:107], v[88:91], v[24:27], 0
  v_mfma_f32_16x16x32_bf16 v[108:111], v[88:91], v[28:31], 0
  v_mfma_f32_16x16x32_bf16 v[112:115], v[88:91], v[32:35], 0
  v_mfma_f32_16x16x32_bf16 v[116:119], v[88:91], v[36:39], 0
  s_waitcnt lgkmcnt(15)
  v_mfma_f32_16x16x32_bf16 v[104:107], v[92:95], v[40:43], v[104:107]
  v_mfma_f32_16x16x32_bf16 v[108:111], v[92:95], v[44:47], v[108:111]
  v_mfma_f32_16x16x32_bf16 v[112:115], v[92:95], v[48:51], v[112:115]
  v_mfma_f32_16x16x32_bf16 v[116:119], v[92:95], v[52:55], v[116:119]
  s_waitcnt lgkmcnt(8)
  v_mfma_f32_16x16x32_bf16 v[104:107], v[96:99], v[56:59], v[104:107]
  v_mfma_f32_16x16x32_bf16 v[108:111], v[96:99], v[60:63], v[108:111]
  v_mfma_f32_16x16x32_bf16 v[112:115], v[96:99], v[64:67], v[112:115]
  v_mfma_f32_16x16x32_bf16 v[116:119], v[96:99], v[68:71], v[116:119]
  s_waitcnt lgkmcnt(0)
  v_mfma_f32_16x16x32_bf16 v[104:107], v[100:103], v[72:75], v[104:107]
  v_mfma_f32_16x16x32_bf16 v[108:111], v[100:103], v[76:79], v[108:111]
  v_mfma_f32_16x16x32_bf16 v[112:115], v[100:103], v[80:83], v[112:115]
  v_mfma_f32_16x16x32_bf16 v[116:119], v[100:103], v[84:87], v[116:119]
  s_nop 7
  v_perm_b32 v8, v104, v116, s52
  v_perm_b32 v9, v108, v116, s53
  v_perm_b32 v10, v112, v116, s54
  s_mov_b32 exec_hi, 0
  v_readfirstlane_b32 s48, v13
  global_store_dwordx4 v22, v[8:11], s[32:33]
  s_mov_b32 exec_hi, -1
  s_branch L_sent_24
L_spin_23:
  s_sleep 2
L_sent_24:
  ds_read_b32 v12, v7 offset:16
  s_waitcnt lgkmcnt(0)
  v_readfirstlane_b32 s7, v12
  s_nop 0
  s_cmp_lt_u32 s7, 16
  s_cbranch_scc1 L_spin_23
  global_load_dwordx4 v[24:27], v21, s[32:33] offset:0 sc1
  global_load_dwordx4 v[28:31], v21, s[32:33] offset:1024 sc1
  global_load_dwordx4 v[32:35], v21, s[32:33] offset:2048 sc1
  global_load_dwordx4 v[36:39], v21, s[32:33] offset:3072 sc1
  ds_read_b32 v13, v7 offset:36
  s_waitcnt lgkmcnt(0)
  v_readfirstlane_b32 s48, v13
  s_nop 0
  s_cmp_eq_u32 s48, 1
  s_cbranch_scc1 L_lz_25
  s_mov_b32 exec_hi, 0
  global_store_dwordx4 v22, v[8:11], s[30:31] sc1
  s_mov_b32 exec_hi, -1
L_lz_25:
  s_mov_b32 s36, 0
  s_branch L_pchk_27
L_poll_26:
  s_and_b32 s37, s36, 15
  s_cmp_eq_u32 s37, 15
  s_cbranch_scc1 L_pgl_28
  global_load_dwordx4 v[24:27], v21, s[32:33] offset:0 sc1
  global_load_dwordx4 v[28:31], v21, s[32:33] offset:1024 sc1
  global_load_dwordx4 v[32:35], v21, s[32:33] offset:2048 sc1
  global_load_dwordx4 v[36:39], v21, s[32:33] offset:3072 sc1
  s_branch L_pchk_27
L_pgl_28:
  global_load_dwordx4 v[24:27], v21, s[30:31] offset:0 sc1
  global_load_dwordx4 v[28:31], v21, s[30:31] offset:1024 sc1
  global_load_dwordx4 v[32:35], v21, s[30:31] offset:2048 sc1
  global_load_dwordx4 v[36:39], v21, s[30:31] offset:3072 sc1
L_pchk_27:
  s_mov_b64 s[34:35], exec
  s_waitcnt vmcnt(0)
  v_cmpx_eq_u32 vcc, s6, v27
  v_cmpx_eq_u32 vcc, s6, v31
  v_cmpx_eq_u32 vcc, s6, v35
  v_cmpx_eq_u32 vcc, s6, v39
  s_nop 0
  s_andn2_b64 exec, s[34:35], exec
  s_cbranch_scc0 L_pdone_29
  s_sleep 4
  s_add_u32 s36, s36, 1
  s_cmp_lt_u32 s36, 40000
  s_cbranch_scc1 L_poll_26
L_pdone_29:
  s_mov_b64 exec, -1
  s_nop 2
  v_perm_b32 v27, v24, v25, s55
  v_perm_b32 v31, v28, v29, s55
  v_perm_b32 v35, v32, v33, s55
  v_perm_b32 v39, v36, v37, s55
  v_perm_b32 v27, v27, v26, s56
  v_perm_b32 v31, v31, v30, s56
  v_perm_b32 v35, v35, v34, s56
  v_perm_b32 v39, v39, v38, s56
  v_pk_add_f32 v[24:25], v[24:25], v[28:29]
  v_pk_add_f32 v[32:33], v[32:33], v[36:37]
  v_pk_add_f32 v[26:27], v[26:27], v[30:31]
  v_pk_add_f32 v[34:35], v[34:35], v[38:39]
  v_pk_add_f32 v[24:25], v[24:25], v[32:33]
  v_pk_add_f32 v[26:27], v[26:27], v[34:35]
  s_nop 0
  v_permlane32_swap_b32 v24, v25
  v_permlane32_swap_b32 v26, v27
  v_add_f32 v8, v24, v25
  v_add_f32 v9, v26, v27
  s_nop 1
  v_permlane16_swap_b32 v8, v9
  v_cvt_pk_bf16_f32 v9, v8, v9
  v_lshlrev_b32 v8, 16, v9
  v_and_b32 v9, 0xffff0000, v9
  v_mov_b32 v11, 0xc0135761
  v_mul_f32 v10, v8, v8
  v_fmac_f32 v11, 0xbdd2d3e8, v10
  v_mul_f32 v10, v11, v8
  v_exp_f32 v10, v10
  s_nop 0
  v_add_f32 v10, 1.0, v10
  v_rcp_f32 v10, v10
  s_nop 0
  v_mul_f32 v10, v10, v8
  v_cvt_pk_bf16_f32 v10, v10, v10
  v_lshlrev_b32 v10, 16, v10
  v_mul_f32 v10, v10, v9
  v_cvt_pk_bf16_f32 v10, v10, v10
  ds_write_b16 v23, v10 offset:3072
  v_mov_b32 v12, 1
  ds_write_b32 v7, v12 offset:40
  s_endpgm
  .fill ((4096 - (. - recurrent_scan__sliding_block_cached__geglu_ffn__decode_kernel) % 4096) % 4096) / 4, 4, 0xbf800000
L_W2:
  v_and_b32 v3, 15, v1
  v_lshrrev_b32 v4, 4, v1
  s_mov_b32 s52, 0x07060503
  s_mov_b32 s53, 0x07060502
  s_mov_b32 s54, 0x07060501
  s_mov_b32 s55, 0x04000c0c
  s_mov_b32 s56, 0x0706000c
  s_and_b32 s43, s5, 24
  s_add_u32 s44, s4, 7
  s_and_b32 s44, s44, 7
  s_lshr_b32 s62, s5, 3
  s_lshl2_add_u32 s44, s44, s62
  s_and_b32 s45, s5, 7
  v_mov_b64 v[20:21], 0
  v_mov_b64 v[22:23], 0
  v_mov_b64 v[64:65], 0
  v_mov_b64 v[66:67], 0
  v_mov_b64 v[68:69], 0
  v_mov_b64 v[70:71], 0
  v_mov_b64 v[72:73], 0
  v_mov_b64 v[74:75], 0
  v_mov_b64 v[76:77], 0
  v_mov_b64 v[78:79], 0
  v_mov_b64 v[104:105], 0
  v_mov_b64 v[106:107], 0
  v_mov_b64 v[108:109], 0
  v_mov_b64 v[110:111], 0
  s_lshr_b32 s41, s5, 3
  s_lshl2_add_u32 s47, s4, s41
  v_lshrrev_b32 v12, 2, v1
  v_lshlrev_b32 v12, 7, v12
  v_and_b32 v14, 3, v1
  v_lshl_add_u32 v12, v14, 3, v12
  v_bfe_u32 v13, v1, 3, 2
  v_xor_b32 v13, s46, v13
  v_lshl_add_u32 v12, v13, 5, v12
  v_add_u32 v16, 110592, v12
  v_lshlrev_b32 v112, 4, v4
  s_lshl_b32 s40, s47, 15
  s_add_u32 s40, s40, 1048576
  s_lshl_b32 s41, s46, 12
  s_add_u32 s41, s41, s40
  v_lshlrev_b32 v2, 4, v1
  v_add_u32 v114, s41, v2
  s_add_u32 s41, s40, 16384
  v_and_b32 v15, 56, v1
  v_lshlrev_b32 v14, 4, v14
  v_lshl_add_u32 v115, v15, 3, v14
  v_add_u32 v115, s41, v115
  s_lshl_b32 s41, s46, 6
  v_and_b32 v15, 4, v1
  v_lshl_add_u32 v119, v15, 1, v14
  v_and_b32 v15, 1, v4
  v_lshl_add_u32 v119, v15, 2, v119
  v_and_b32 v15, 2, v4
  v_add3_u32 v119, v119, v15, s41
  s_lshl_b32 s40, s45, 15
  s_lshl_b32 s41, s47, 7
  s_add_u32 s40, s40, s41
  s_and_b32 s41, s46, 2
  s_add_u32 s41, s41, s46
  s_lshl_b32 s41, s41, 12
  s_add_u32 s40, s40, s41
  s_add_u32 s40, s40, 262144
  v_and_b32 v15, 8, v1
  v_lshl_add_u32 v120, v15, 3, v112
  v_and_b32 v15, 1, v1
  v_lshl_add_u32 v120, v15, 13, v120
  v_add_u32 v120, s40, v120
  s_waitcnt lgkmcnt(0)
  s_add_u32 s32, s30, 4194304
  s_addc_u32 s33, s31, 0
  s_cmp_lg_u32 s46, 0
  s_cbranch_scc1 L_np_88
  s_lshl_b32 s40, s47, 15
  s_mul_i32 s41, s45, 2176
  s_add_u32 s40, s40, s41
  s_add_u32 s40, s40, 1048576
  v_lshlrev_b32 v12, 7, v1
  v_add_u32 v12, s40, v12
  s_branch L_sent_90
L_spin_89:
  s_sleep 3
L_sent_90:
  ds_read_b32 v13, v7 offset:60
  s_waitcnt lgkmcnt(0)
  v_readfirstlane_b32 s7, v13
  s_nop 0
  s_cmp_lt_u32 s7, 16
  s_cbranch_scc1 L_spin_89
  s_mov_b64 exec, 0x1ffff
  global_load_dword v121, v12, s[32:33] sc1
  s_mov_b64 exec, -1
L_np_88:
  s_lshl2_add_u32 s40, s4, s46
  s_cmp_lg_u32 s40, 7
  s_cbranch_scc1 L_zw_91
  s_lshr_b32 s41, s5, 1
  s_lshl_b32 s41, s41, 14
  s_and_b32 s42, s5, 1
  s_lshl_b32 s42, s42, 12
  s_add_u32 s41, s41, s42
  s_add_u32 s41, s41, 524288
  v_lshlrev_b32 v12, 7, v3
  v_and_b32 v13, 1, v4
  v_lshl_add_u32 v12, v13, 13, v12
  v_add_u32 v12, s41, v12
  s_mov_b64 exec, 33489407
  global_load_dword v121, v12, s[30:31]
  s_mov_b64 exec, -1
L_zw_91:
  s_branch L_sent_93
L_spin_92:
  s_sleep 3
L_sent_93:
  ds_read_b32 v12, v7 offset:32
  s_waitcnt lgkmcnt(0)
  v_readfirstlane_b32 s6, v12
  s_nop 0
  s_cmp_lt_u32 s6, 1
  s_cbranch_scc1 L_spin_92
  ds_read_b32 v13, v7 offset:36
  s_branch L_sent_95
L_spin_94:
  s_sleep 2
L_sent_95:
  ds_read_b32 v12, v7 offset:16
  s_waitcnt lgkmcnt(0)
  v_readfirstlane_b32 s7, v12
  s_nop 0
  s_cmp_lt_u32 s7, 8
  s_cbranch_scc1 L_spin_94
  v_readfirstlane_b32 s64, v13
  s_nop 0
  s_lshl2_add_u32 s64, s4, s64
  s_lshl2_add_u32 s40, s5, s46
  s_lshl2_add_u32 s40, s40, 786432
  v_mov_b32 v17, s40
  s_xor_b32 s40, s6, 2
  v_mov_b32 v11, s40
  s_mov_b32 exec_lo, 50529027
  s_mov_b32 exec_hi, 50529027
  s_cmp_eq_u32 s64, 1
  s_cbranch_scc1 L_zs_96
  global_store_dwordx4 v120, v[8:11], s[30:31] sc1
  s_branch L_zt_97
L_zs_96:
  global_store_dwordx4 v120, v[8:11], s[30:31]
L_zt_97:
  s_mov_b64 exec, -1
  s_cmp_ge_u32 s44, 28
  s_cbranch_scc1 L_nod_98
  s_branch L_sent_100
L_spin_99:
  s_sleep 1
L_sent_100:
  ds_read_b32 v12, v7 offset:20
  s_waitcnt lgkmcnt(0)
  v_readfirstlane_b32 s7, v12
  s_nop 0
  s_cmp_lt_u32 s7, 8
  s_cbranch_scc1 L_spin_99
  ds_read_b64_tr_b16 v[56:57], v16 offset:0
  ds_read_b64_tr_b16 v[58:59], v16 offset:2048
  ds_read_b64_tr_b16 v[60:61], v16 offset:4096
  ds_read_b64_tr_b16 v[62:63], v16 offset:6144
L_nod_98:
  v_mov_b32 v116, 0
  v_add_u32 v118, 31744, v114
  v_mov_b32 v122, v114
  v_mov_b32 v123, v114
  s_movk_i32 s48, -1024
  s_brev_b32 s49, 1
  s_cmp_ge_u32 s44, 28
  s_cselect_b32 s38, 1, 0
  s_mov_b32 s39, 0
  s_mov_b64 s[58:59], s[32:33]
  s_branch L_sent_102
L_spin_101:
  s_sleep 1
L_sent_102:
  ds_read2_b32 v[12:13], v7 offset0:12 offset1:6
  s_waitcnt lgkmcnt(0)
  v_readfirstlane_b32 s7, v12
  v_readfirstlane_b32 s40, v13
  s_cmp_lt_u32 s7, 4
  s_cbranch_scc1 L_spin_101
  s_cmp_lt_u32 s40, 8
  s_cbranch_scc1 L_spin_101
  s_setprio 3
  global_load_dwordx4 v[100:103], v115, s[32:33] offset:0 sc1
  global_load_dwordx4 v[80:83], v114, s[32:33] offset:0 sc1
  global_load_dwordx4 v[84:87], v114, s[32:33] offset:1024 sc1
  global_load_dwordx4 v[88:91], v114, s[32:33] offset:2048 sc1
  global_load_dwordx4 v[92:95], v114, s[32:33] offset:3072 sc1
  s_cmp_lg_u32 s38, 0
  s_cbranch_scc1 L_nod_103
  ds_read_b32 v13, v7 offset:40
  s_mov_b32 exec_lo, 4278255360
  s_mov_b32 exec_hi, 4278255360
  ds_read_b128 v[104:107], v112 offset:3072
  ds_read_b128 v[108:111], v112 offset:3136
  s_mov_b64 exec, -1
  s_waitcnt lgkmcnt(0)
  v_readfirstlane_b32 s38, v13
  s_nop 0
  s_cmp_eq_u32 s38, 0
  s_cbranch_scc1 L_nod_103
  v_mfma_f32_16x16x32_bf16 v[20:23], v[56:59], v[104:107], v[20:23]
  v_mfma_f32_16x16x32_bf16 v[20:23], v[60:63], v[108:111], v[20:23]
L_nod_103:
  s_waitcnt vmcnt(4)
  v_cmp_ne_u32 vcc, s6, v103
  s_cbranch_vccz L_W_l
  s_mov_b32 s36, 0
L_poll_104:
  s_and_b32 s37, s36, 15
  s_cmp_eq_u32 s37, 15
  s_cbranch_scc1 L_pgl_106
  global_load_dwordx4 v[100:103], v115, s[32:33] offset:0 sc1
  s_branch L_pchk_105
L_pgl_106:
  global_load_dwordx4 v[100:103], v115, s[30:31] offset:0 sc1
L_pchk_105:
  s_mov_b64 s[34:35], exec
  s_waitcnt vmcnt(0)
  v_cmpx_eq_u32 vcc, s6, v103
  s_nop 0
  s_andn2_b64 exec, s[34:35], exec
  s_cbranch_scc0 L_pdone_107
  s_sleep 1
  s_add_u32 s36, s36, 1
  s_cmp_lt_u32 s36, 40000
  s_cbranch_scc1 L_poll_104
L_pdone_107:
  s_mov_b64 exec, -1
  s_nop 2
  global_load_dwordx4 v[80:83], v114, s[32:33] offset:0 sc1
  global_load_dwordx4 v[84:87], v114, s[32:33] offset:1024 sc1
  global_load_dwordx4 v[88:91], v114, s[32:33] offset:2048 sc1
  global_load_dwordx4 v[92:95], v114, s[32:33] offset:3072 sc1
L_W_l:
  v_cmp_lg_f32 vcc, 0, v100
  v_add_f32_dpp v113, v101, v101 quad_perm:[1,0,3,2] row_mask:0xf bank_mask:0xf
  s_mov_b32 s36, 0
  s_cbranch_vccnz L_W_slow
  v_add_f32_dpp v113, v113, v113 quad_perm:[2,3,0,1] row_mask:0xf bank_mask:0xf
  ds_read_b32 v14, v7 offset:24
  ds_read_b64_tr_b16 v[40:41], v16 offset:8192
  v_add_f32_dpp v113, v113, v113 row_ror:8 row_mask:0xf bank_mask:0xf
  ds_read_b64_tr_b16 v[42:43], v16 offset:10240
  ds_read_b64_tr_b16 v[44:45], v16 offset:12288
  v_add_f32_dpp v113, v113, v113 row_bcast:15 row_mask:0xa bank_mask:0xf
  ds_read_b64_tr_b16 v[46:47], v16 offset:14336
  ds_read_b64_tr_b16 v[48:49], v16 offset:16384
  v_add_f32_dpp v113, v113, v113 row_bcast:31 row_mask:0xc bank_mask:0xf
  s_cmp_lg_u32 s39, 0
  v_rcp_f32 v113, v113
  ds_read_b64_tr_b16 v[50:51], v16 offset:18432
  ds_read_b64_tr_b16 v[52:53], v16 offset:20480
  ds_read_b64_tr_b16 v[54:55], v16 offset:22528
  v_readlane_b32 s57, v113, 63
  s_cbranch_scc1 L_W_slow2
  s_waitcnt vmcnt(0)
  v_cmp_ne_u32 s[62:63], s6, v83
  v_cmp_ne_u32 s[66:67], s6, v87
  v_cmp_ne_u32 s[68:69], s6, v91
  v_cmp_ne_u32 s[42:43], s6, v95
  s_or_b64 s[40:41], s[62:63], s[66:67]
  s_or_b64 s[60:61], s[68:69], s[42:43]
  s_or_b64 s[60:61], s[60:61], s[40:41]
  s_cbranch_scc0 L_W_acc
  s_mov_b64 exec, s[60:61]
  v_addc_co_u32 v116, vcc, v116, v116, s[42:43]
  v_addc_co_u32 v116, vcc, v116, v116, s[68:69]
  v_addc_co_u32 v116, vcc, v116, v116, s[66:67]
  v_addc_co_u32 v116, vcc, v116, v116, s[62:63]
  v_ffbl_b32 v12, v116
  v_ffbh_u32 v117, v116
  v_lshl_add_u32 v122, v12, 10, v114
  global_load_dwordx4 v[24:27], v122, s[32:33] sc1
  v_mad_i32_i24 v123, v117, s48, v118
  s_mov_b64 exec, s[62:63]
  v_mov_b64 v[80:81], 0
  v_mov_b32 v82, 0
  s_mov_b64 exec, s[66:67]
  v_mov_b64 v[84:85], 0
  v_mov_b32 v86, 0
  s_mov_b64 exec, s[68:69]
  v_mov_b64 v[88:89], 0
  v_mov_b32 v90, 0
  s_mov_b64 exec, s[42:43]
  v_mov_b64 v[92:93], 0
  v_mov_b32 v94, 0
  s_mov_b64 exec, s[60:61]
  v_cmp_ne_u32 s[62:63], v122, v123
  global_load_dwordx4 v[28:31], v123, s[32:33] sc1
  s_mov_b64 exec, -1
L_W_acc:
  v_perm_b32 v83, v80, v81, s55
  v_perm_b32 v87, v84, v85, s55
  v_perm_b32 v91, v88, v89, s55
  v_perm_b32 v95, v92, v93, s55
  v_pk_add_f32 v[8:9], v[80:81], v[84:85]
  v_pk_add_f32 v[12:13], v[88:89], v[92:93]
  v_perm_b32 v83, v83, v82, s56
  v_perm_b32 v87, v87, v86, s56
  v_perm_b32 v91, v91, v90, s56
  v_perm_b32 v95, v95, v94, s56
  v_pk_add_f32 v[8:9], v[8:9], v[12:13]
  v_pk_add_f32 v[10:11], v[82:83], v[86:87]
  v_pk_add_f32 v[12:13], v[90:91], v[94:95]
  v_pk_add_f32 v[10:11], v[10:11], v[12:13]
  s_cbranch_scc0 L_W_go
  s_mov_b64 exec, s[60:61]
  s_branch L_W_w1
L_W_slow:
  v_mov_b32 v12, v100
  s_nop 1
  v_max_f32_dpp v12, v12, v12 quad_perm:[1,0,3,2] row_mask:0xf bank_mask:0xf
  s_nop 1
  v_max_f32_dpp v12, v12, v12 quad_perm:[2,3,0,1] row_mask:0xf bank_mask:0xf
  s_nop 1
  v_max_f32_dpp v12, v12, v12 row_ror:8 row_mask:0xf bank_mask:0xf
  v_mov_b32 v13, v12
  s_nop 1
  v_permlane16_swap_b32 v12, v13
  v_max_f32 v12, v12, v13
  v_mov_b32 v13, v12
  s_nop 1
  v_permlane32_swap_b32 v12, v13
  v_max_f32 v12, v12, v13
  v_sub_f32 v12, v100, v12
  v_exp_f32 v12, v12
  v_mov_b32 v100, 0
  s_mov_b32 s39, 1
  v_mul_f32 v101, v101, v12
  v_mov_b32_dpp v96, v12 quad_perm:[0,0,0,0] row_mask:0xf bank_mask:0xf
  v_mov_b32_dpp v97, v12 quad_perm:[1,1,1,1] row_mask:0xf bank_mask:0xf
  v_mov_b32_dpp v98, v12 quad_perm:[2,2,2,2] row_mask:0xf bank_mask:0xf
  v_mov_b32_dpp v99, v12 quad_perm:[3,3,3,3] row_mask:0xf bank_mask:0xf
  s_branch L_W_l
L_W_slow2:
  s_mov_b32 s36, 0
  s_branch L_pchk_109
L_poll_108:
  s_and_b32 s37, s36, 15
  s_cmp_eq_u32 s37, 15
  s_cbranch_scc1 L_pgl_110
  global_load_dwordx4 v[80:83], v114, s[32:33] offset:0 sc1
  global_load_dwordx4 v[84:87], v114, s[32:33] offset:1024 sc1
  global_load_dwordx4 v[88:91], v114, s[32:33] offset:2048 sc1
  global_load_dwordx4 v[92:95], v114, s[32:33] offset:3072 sc1
  s_branch L_pchk_109
L_pgl_110:
  global_load_dwordx4 v[80:83], v114, s[30:31] offset:0 sc1
  global_load_dwordx4 v[84:87], v114, s[30:31] offset:1024 sc1
  global_load_dwordx4 v[88:91], v114, s[30:31] offset:2048 sc1
  global_load_dwordx4 v[92:95], v114, s[30:31] offset:3072 sc1
L_pchk_109:
  s_mov_b64 s[34:35], exec
  s_waitcnt vmcnt(0)
  v_cmpx_eq_u32 vcc, s6, v83
  v_cmpx_eq_u32 vcc, s6, v87
  v_cmpx_eq_u32 vcc, s6, v91
  v_cmpx_eq_u32 vcc, s6, v95
  s_nop 0
  s_andn2_b64 exec, s[34:35], exec
  s_cbranch_scc0 L_pdone_111
  s_add_u32 s36, s36, 1
  s_cmp_lt_u32 s36, 40000
  s_cbranch_scc1 L_poll_108
L_pdone_111:
  s_mov_b64 exec, -1
  s_nop 2
  v_perm_b32 v83, v80, v81, s55
  v_perm_b32 v87, v84, v85, s55
  v_perm_b32 v91, v88, v89, s55
  v_perm_b32 v95, v92, v93, s55
  v_pk_mul_f32 v[8:9], v[80:81], v[96:97] op_sel_hi:[1,0]
  v_perm_b32 v83, v83, v82, s56
  v_pk_fma_f32 v[8:9], v[84:85], v[96:97], v[8:9] op_sel:[0,1,0]
  v_perm_b32 v87, v87, v86, s56
  v_pk_fma_f32 v[8:9], v[88:89], v[98:99], v[8:9] op_sel_hi:[1,0,1]
  v_perm_b32 v91, v91, v90, s56
  v_pk_fma_f32 v[8:9], v[92:93], v[98:99], v[8:9] op_sel:[0,1,0]
  v_perm_b32 v95, v95, v94, s56
  v_pk_mul_f32 v[10:11], v[82:83], v[96:97] op_sel_hi:[1,0]
  v_pk_fma_f32 v[10:11], v[86:87], v[96:97], v[10:11] op_sel:[0,1,0]
  v_pk_fma_f32 v[10:11], v[90:91], v[98:99], v[10:11] op_sel_hi:[1,0,1]
  v_pk_fma_f32 v[10:11], v[94:95], v[98:99], v[10:11] op_sel:[0,1,0]
  s_branch L_W_go
T_Wp:
  s_branch L_W2
L_W_s1:
  v_perm_b32 v27, v24, v25, s55
  s_andn2_b64 s[40:41], exec, s[62:63]
  v_pk_add_f32 v[8:9], v[8:9], v[24:25]
  v_perm_b32 v27, v27, v26, s56
  s_andn2_b64 s[60:61], s[60:61], s[40:41]
  v_pk_add_f32 v[10:11], v[10:11], v[26:27]
  s_cbranch_scc0 L_W_go
  v_add_u32 v12, -1, v116
  v_and_b32 v116, v12, v116
  v_ffbl_b32 v12, v116
  v_lshl_add_u32 v122, v12, 10, v114
  s_mov_b64 exec, s[60:61]
  v_cmp_ne_u32 s[62:63], v122, v123
  s_branch L_W_m
L_W_s2:
  v_perm_b32 v31, v28, v29, s55
  s_andn2_b64 s[40:41], exec, s[62:63]
  v_pk_add_f32 v[8:9], v[8:9], v[28:29]
  v_perm_b32 v31, v31, v30, s56
  s_andn2_b64 s[60:61], s[60:61], s[40:41]
  v_pk_add_f32 v[10:11], v[10:11], v[30:31]
  s_cbranch_scc0 L_W_go
  v_lshrrev_b32 v12, v117, s49
  v_xor_b32 v116, v12, v116
  v_ffbh_u32 v117, v116
  v_mad_i32_i24 v123, v117, s48, v118
  s_mov_b64 exec, s[60:61]
  v_cmp_ne_u32 s[62:63], v122, v123
L_W_top:
  s_mov_b64 exec, s[60:61]
  global_load_dwordx4 v[28:31], v123, s[58:59] sc1
  s_add_u32 s36, s36, 1
  s_and_b32 s37, s36, 7
  s_cselect_b64 s[58:59], s[32:33], s[30:31]
L_W_w1:
  s_waitcnt vmcnt(1)
  v_cmpx_eq_u32 vcc, s6, v27
  s_cbranch_execnz L_W_s1
  s_mov_b64 exec, s[60:61]
L_W_m:
  global_load_dwordx4 v[24:27], v122, s[32:33] sc1
  s_cmp_lt_u32 s36, 40000
  s_waitcnt vmcnt(1)
  v_cmpx_eq_u32 vcc, s6, v31
  s_cbranch_execnz L_W_s2
  s_cbranch_scc1 L_W_top
  s_nop 1
L_W_go:
  s_mov_b64 exec, -1
  v_permlane32_swap_b32 v8, v9
  v_permlane32_swap_b32 v10, v11
  v_add_f32 v8, v8, v9
  v_add_f32 v9, v10, v11
  v_mov_b32 v12, 1
  s_waitcnt lgkmcnt(0)
  v_permlane16_swap_b32 v8, v9
  v_add_f32 v8, v8, v9
  v_mov_b32 v11, s6
  v_readfirstlane_b32 s37, v14
  v_add_f32_dpp v8, v8, v8 row_ror:8 row_mask:0xf bank_mask:0xf
  v_mul_f32 v8, s57, v8
  v_cvt_pk_bf16_f32 v8, v8, v8
  ds_write_b16 v119, v8 offset:6144
  s_mov_b64 exec, 1
  ds_add_u32 v7, v12 offset:44
  s_cmp_lg_u32 s38, 0
  s_cbranch_scc1 L_hok_112
L_hspin_113:
  ds_read_b32 v13, v7 offset:40
  s_mov_b32 exec_lo, 4278255360
  s_mov_b32 exec_hi, 4278255360
  ds_read_b128 v[104:107], v112 offset:3072
  ds_read_b128 v[108:111], v112 offset:3136
  s_mov_b64 exec, -1
  s_waitcnt lgkmcnt(0)
  v_readfirstlane_b32 s7, v13
  s_nop 0
  s_cmp_eq_u32 s7, 0
  s_cbranch_scc1 L_hspin_113
  v_mfma_f32_16x16x32_bf16 v[20:23], v[56:59], v[104:107], v[20:23]
  v_mfma_f32_16x16x32_bf16 v[20:23], v[60:63], v[108:111], v[20:23]
L_hok_112:
  s_cmp_ge_u32 s37, 16
  s_cbranch_scc1 L_ook_114
  s_mov_b64 exec, -1
  s_branch L_sent_116
L_spin_115:
L_sent_116:
  ds_read_b32 v12, v7 offset:24
  s_waitcnt lgkmcnt(0)
  v_readfirstlane_b32 s7, v12
  s_nop 0
  s_cmp_lt_u32 s7, 16
  s_cbranch_scc1 L_spin_115
  ds_read_b64_tr_b16 v[40:41], v16 offset:8192
  ds_read_b64_tr_b16 v[42:43], v16 offset:10240
  ds_read_b64_tr_b16 v[44:45], v16 offset:12288
  ds_read_b64_tr_b16 v[46:47], v16 offset:14336
  ds_read_b64_tr_b16 v[48:49], v16 offset:16384
  ds_read_b64_tr_b16 v[50:51], v16 offset:18432
  ds_read_b64_tr_b16 v[52:53], v16 offset:20480
  ds_read_b64_tr_b16 v[54:55], v16 offset:22528
L_ook_114:
  s_mov_b32 exec_lo, 16711935
  s_mov_b32 exec_hi, 16711935
L_ospin_117:
  ds_read_b32 v13, v7 offset:44
  ds_read_b128 v[64:67], v112 offset:6144
  ds_read_b128 v[68:71], v112 offset:6208
  ds_read_b128 v[72:75], v112 offset:6272
  ds_read_b128 v[76:79], v112 offset:6336
  s_waitcnt lgkmcnt(4)
  v_readfirstlane_b32 s7, v13
  s_nop 0
  s_cmp_lt_u32 s7, 4
  s_cbranch_scc1 L_ospin_117
  s_mov_b64 exec, -1
  s_waitcnt lgkmcnt(3)
  v_mfma_f32_16x16x32_bf16 v[20:23], v[40:43], v[64:67], v[20:23]
  s_waitcnt lgkmcnt(2)
  v_mfma_f32_16x16x32_bf16 v[20:23], v[44:47], v[68:71], v[20:23]
  s_waitcnt lgkmcnt(1)
  v_mfma_f32_16x16x32_bf16 v[20:23], v[48:51], v[72:75], v[20:23]
  s_waitcnt lgkmcnt(0)
  v_mfma_f32_16x16x32_bf16 v[20:23], v[52:55], v[76:79], v[20:23]
  s_mov_b32 exec_lo, 50529027
  s_mov_b32 exec_hi, 50529027
  s_nop 5
  v_perm_b32 v8, v20, v23, s52
  v_perm_b32 v9, v21, v23, s53
  v_perm_b32 v10, v22, v23, s54
  s_cmp_eq_u32 s64, 1
  s_cbranch_scc1 L_zs_118
  global_store_dwordx4 v120, v[8:11], s[30:31] sc1
  s_branch L_zt_119
L_zs_118:
  global_store_dwordx4 v120, v[8:11], s[30:31]
L_zt_119:
  s_cmp_lg_u32 s4, 0
  s_cbranch_scc1 L_W_nf
  s_mov_b64 exec, 1
  global_store_dword v17, v11, s[30:31]
  v_mov_b32 v12, 1
  ds_add_u32 v7, v12 offset:44
L_W_nf:
  s_mov_b64 exec, -1
L_W_end:
  s_endpgm
T_Z:
  s_branch L_W2
L_Z:
  v_and_b32 v3, 15, v1
  v_lshrrev_b32 v4, 4, v1
  s_mov_b32 s52, 0x07060503
  s_mov_b32 s53, 0x07060502
  s_mov_b32 s54, 0x07060501
  s_mov_b32 s55, 0x04000c0c
  s_mov_b32 s56, 0x0706000c
  s_and_b32 s43, s5, 24
  s_add_u32 s44, s4, 7
  s_and_b32 s44, s44, 7
  s_lshr_b32 s62, s5, 3
  s_lshl2_add_u32 s44, s44, s62
  s_and_b32 s45, s5, 7
  s_lshl_b32 s40, s45, 2
  s_add_u32 s40, s40, s44
  s_sub_u32 s40, s40, 28
  s_lshr_b32 s41, s40, 1
  s_lshl_b32 s41, s41, 14
  s_and_b32 s42, s40, 1
  s_lshl_b32 s42, s42, 12
  s_add_u32 s41, s41, s42
  s_add_u32 s42, s41, 524288
  s_add_u32 s58, s30, s42
  s_addc_u32 s59, s31, 0
  s_add_u32 s41, s41, 262144
  v_and_b32 v12, 56, v1
  v_mad_u32_u24 v12, v12, 3, v1
  v_lshlrev_b32 v21, 4, v12
  v_add_u32 v21, s41, v21
  s_lshl_b32 s41, s45, 7
  s_and_b32 s42, s40, 3
  s_lshl_b32 s42, s42, 5
  s_add_u32 s41, s41, s42
  v_and_b32 v22, 3, v1
  v_lshlrev_b32 v22, 3, v22
  v_and_b32 v12, 1, v4
  v_lshl_add_u32 v22, v12, 2, v22
  v_and_b32 v12, 2, v4
  v_lshl_add_u32 v22, v12, 0, v22
  v_add_u32 v22, s41, v22
  global_load_ushort v23, v22, s[8:9]
  v_lshlrev_b32 v17, 3, v1
  v_add_u32 v17, 786432, v17
  s_cmp_lg_u32 s40, 1
  s_cbranch_scc1 L_et_p
  global_load_dword v13, v17, s[30:31] sc1
L_et_p:
  s_branch L_sent_31
L_spin_30:
  s_sleep 2
L_sent_31:
  ds_read_b32 v12, v7 offset:16
  s_waitcnt lgkmcnt(0)
  v_readfirstlane_b32 s7, v12
  s_nop 0
  s_cmp_lt_u32 s7, 32
  s_cbranch_scc1 L_spin_30
  s_setprio 3
  s_movk_i32 s46, 8064
L_rtop_32:
  s_waitcnt lgkmcnt(0)
  s_add_u32 s57, s46, 128
  s_xor_b32 s46, s57, 8192
  s_mov_b32 s60, s6
  s_load_dword s61, s[58:59], s46
  s_load_dword s60, s[58:59], s57
  s_mov_b32 s47, 0
  s_waitcnt lgkmcnt(1)
  s_cmp_eq_u32 s60, s6
  s_addc_u32 s47, s47, 0
  s_cmp_eq_u32 s60, s6
  s_addc_u32 s47, s47, 0
  s_cmp_eq_u32 s60, s6
  s_addc_u32 s47, s47, 0
  s_cmp_eq_u32 s60, s6
  s_addc_u32 s47, s47, 0
  s_cmp_eq_u32 s60, s6
  s_addc_u32 s47, s47, 0
  s_cmp_eq_u32 s60, s6
  s_addc_u32 s47, s47, 0
  s_cmp_eq_u32 s60, s6
  s_addc_u32 s47, s47, 0
  s_cmp_eq_u32 s60, s6
  s_addc_u32 s47, s47, 0
  s_bitcmp1_b32 s46, 10
  s_cbranch_scc1 L_raced_34
  s_cmp_lt_u32 s47, 8
  s_cbranch_scc1 L_rtop_32
L_raced_34:
  s_and_b32 s42, s46, 8192
  v_add_u32 v21, s42, v21
  s_setprio 0
  v_and_b32 v16, 31, v1
  v_lshlrev_b32 v16, 7, v16
  s_add_u32 s42, s42, 262152
  v_add_u32 v16, s42, v16
  s_mov_b32 s42, 2
  s_mov_b32 s44, -1
  s_mov_b32 s43, 40000
  s_cmp_lg_u32 s40, 1
  s_cbranch_scc1 L_et_a
  v_mov_b32 v16, v17
  s_mov_b32 s42, 0
  s_mov_b32 s44, 0
  s_mov_b32 s43, 8
L_et_a:
  s_or_b32 s41, s6, s42
  v_mov_b32 v10, s6
  s_mov_b32 s36, 0
  s_branch L_sent_36
L_spin_35:
  s_sleep 2
L_sent_36:
  ds_read_b32 v12, v7 offset:44
  s_waitcnt lgkmcnt(0)
  v_readfirstlane_b32 s7, v12
  s_nop 0
  s_cmp_lt_u32 s7, 8
  s_cbranch_scc1 L_spin_35
  s_cmp_gt_u32 s40, 1
  s_cbranch_scc1 L_et_end
L_et:
  global_load_dwordx2 v[12:13], v16, s[30:31] sc1
  s_add_u32 s36, s36, 1
  s_cmp_le_u32 s36, s43
  s_waitcnt vmcnt(0)
  v_bfi_b32 v12, s44, v13, v12
  v_xor_b32 v12, v12, v13
  v_or_b32 v13, s42, v13
  v_xor_b32 v13, s41, v13
  v_or_b32 v13, v13, v12
  v_cmpx_ne_u32 vcc, 0, v13
  s_cbranch_execz L_et_go
  s_cbranch_scc1 L_et
L_et_go:
  s_cmp_eq_u32 s40, 1
  s_cbranch_scc1 L_et_wb
  s_mov_b64 exec, 1
  global_store_dword v7, v10, s[30:31] sc1
  s_movk_i32 s36, 99
L_et_wb:
  s_mov_b64 exec, -1
  s_cmp_gt_u32 s36, 8
  s_cbranch_scc1 L_et_end
  buffer_wbl2 sc1
L_et_end:
  s_setprio 3
  global_load_dwordx4 v[24:27], v21, s[30:31] offset:0 sc1
  global_load_dwordx4 v[28:31], v21, s[30:31] offset:128 sc1
  global_load_dwordx4 v[32:35], v21, s[30:31] offset:256 sc1
  global_load_dwordx4 v[36:39], v21, s[30:31] offset:384 sc1
  s_mov_b32 s36, 0
  s_mov_b64 s[60:61], -1
  s_waitcnt vmcnt(4)
  v_lshlrev_b32 v23, 16, v23
  s_sleep 2
L_ztop_40:
  s_mov_b64 exec, s[60:61]
  global_load_dwordx4 v[40:43], v21, s[30:31] offset:0 sc1
  global_load_dwordx4 v[44:47], v21, s[30:31] offset:128 sc1
  global_load_dwordx4 v[48:51], v21, s[30:31] offset:256 sc1
  global_load_dwordx4 v[52:55], v21, s[30:31] offset:384 sc1
  s_sleep 2
  s_waitcnt vmcnt(4)
  v_cmpx_eq_u32 vcc, s6, v27
  v_cmpx_eq_u32 vcc, s6, v31
  v_cmpx_eq_u32 vcc, s6, v35
  v_cmpx_eq_u32 vcc, s6, v39
  s_cbranch_execz L_znx_41
  v_perm_b32 v27, v24, v25, s55
  v_perm_b32 v31, v28, v29, s55
  v_perm_b32 v35, v32, v33, s55
  v_perm_b32 v39, v36, v37, s55
  v_pk_add_f32 v[12:13], v[24:25], v[28:29]
  v_pk_add_f32 v[16:17], v[32:33], v[36:37]
  v_perm_b32 v27, v27, v26, s56
  v_perm_b32 v31, v31, v30, s56
  v_perm_b32 v35, v35, v34, s56
  v_perm_b32 v39, v39, v38, s56
  s_andn2_b64 s[60:61], s[60:61], exec
  v_pk_add_f32 v[14:15], v[26:27], v[30:31]
  v_pk_add_f32 v[18:19], v[34:35], v[38:39]
  s_cbranch_scc0 L_zgot_39
L_znx_41:
  s_mov_b64 exec, s[60:61]
  global_load_dwordx4 v[24:27], v21, s[30:31] offset:0 sc1
  global_load_dwordx4 v[28:31], v21, s[30:31] offset:128 sc1
  global_load_dwordx4 v[32:35], v21, s[30:31] offset:256 sc1
  global_load_dwordx4 v[36:39], v21, s[30:31] offset:384 sc1
  s_sleep 2
  s_waitcnt vmcnt(4)
  v_cmpx_eq_u32 vcc, s6, v43
  v_cmpx_eq_u32 vcc, s6, v47
  v_cmpx_eq_u32 vcc, s6, v51
  v_cmpx_eq_u32 vcc, s6, v55
  s_cbranch_execz L_znx_42
  v_perm_b32 v43, v40, v41, s55
  v_perm_b32 v47, v44, v45, s55
  v_perm_b32 v51, v48, v49, s55
  v_perm_b32 v55, v52, v53, s55
  v_pk_add_f32 v[12:13], v[40:41], v[44:45]
  v_pk_add_f32 v[16:17], v[48:49], v[52:53]
  v_perm_b32 v43, v43, v42, s56
  v_perm_b32 v47, v47, v46, s56
  v_perm_b32 v51, v51, v50, s56
  v_perm_b32 v55, v55, v54, s56
  s_andn2_b64 s[60:61], s[60:61], exec
  v_pk_add_f32 v[14:15], v[42:43], v[46:47]
  v_pk_add_f32 v[18:19], v[50:51], v[54:55]
  s_cbranch_scc0 L_zgot_39
L_znx_42:
  s_add_u32 s36, s36, 1
  s_cmp_lt_u32 s36, 40000
  s_cbranch_scc1 L_ztop_40
L_zgot_39:
  s_mov_b64 exec, -1
  v_pk_add_f32 v[12:13], v[12:13], v[16:17]
  v_pk_add_f32 v[14:15], v[14:15], v[18:19]
  s_nop 0
  v_permlane32_swap_b32 v12, v13
  v_permlane32_swap_b32 v14, v15
  v_add_f32 v8, v12, v13
  v_add_f32 v9, v14, v15
  s_nop 1
  v_permlane16_swap_b32 v8, v9
  v_add_f32 v8, v8, v9
  s_nop 1
  v_add_f32_dpp v8, v8, v8 row_ror:8 row_mask:0xf bank_mask:0xf
  v_cvt_pk_bf16_f32 v8, v8, v8
  v_lshlrev_b32 v8, 16, v8
  v_mul_f32 v9, 0xbfb8aa3b, v8
  v_exp_f32 v9, v9
  s_nop 0
  v_add_f32 v9, 1.0, v9
  v_rcp_f32 v9, v9
  s_nop 0
  v_mul_f32 v9, v9, v8
  v_cvt_pk_bf16_f32 v9, v9, v9
  v_lshlrev_b32 v9, 16, v9
  s_nop 1
  v_mul_f32_dpp v8, v9, v8 row_shl:4 row_mask:0xf bank_mask:0xf bound_ctrl:0
  v_cvt_pk_bf16_f32 v8, v8, v8
  v_lshlrev_b32 v8, 16, v8
  v_add_f32 v8, v8, v23
  v_cvt_pk_bf16_f32 v8, v8, v8
  s_mov_b32 exec_lo, 983055
  s_mov_b32 exec_hi, 983055
  global_store_short v22, v8, s[26:27]
L_Z_end:
  s_mov_b64 exec, -1
  s_endpgm
L_end:
  s_endpgm
  .fill (16384 - (. - recurrent_scan__sliding_block_cached__geglu_ffn__decode_kernel)) / 4, 4, 0xbf810000
.section .rodata,"a"
.p2align 6
.amdhsa_kernel recurrent_scan__sliding_block_cached__geglu_ffn__decode_kernel
  .amdhsa_next_free_vgpr 128
  .amdhsa_next_free_sgpr 102
  .amdhsa_accum_offset 128
  .amdhsa_group_segment_fixed_size 0
  .amdhsa_kernarg_size 96
  .amdhsa_user_sgpr_count 2
  .amdhsa_user_sgpr_kernarg_segment_ptr 1
  .amdhsa_system_sgpr_workgroup_id_x 1
  .amdhsa_float_denorm_mode_32 3
.end_amdhsa_kernel
```
